```python
import torch

def _softmax(x, axis=-1):
    return torch.softmax(x, dim=axis)
def _gelu(x):
    return torch.nn.functional.gelu(x, approximate="tanh")
def _silu(x):
    return torch.nn.functional.silu(x)
def _sigmoid(x):
    return torch.sigmoid(x)
def _layernorm(x, axis=-1, eps=1e-5):
    m = x.mean(dim=axis, keepdim=True)
    v = x.var(dim=axis, keepdim=True, unbiased=False)
    return (x - m) / torch.sqrt(v + eps)
def _scatter_add(tgt, idx, src, axis=0):
    return tgt.clone().index_add_(axis, idx, src)
def _segment_sum(src, seg, n):
    out = torch.zeros((n,) + src.shape[1:], dtype=src.dtype)
    return out.index_add_(0, seg, src)
def _pad(x, pw):
    flat = tuple(v for pair in reversed(pw) for v in pair)
    return torch.nn.functional.pad(x, flat)

kernel_name = 'parallel_sum__ssm_conv_h3__dense_activation_relu__prompt'

def setup_inputs():

    _w = (lambda a: (lambda t: t.to(torch.bfloat16) if t.is_floating_point() else t)(torch.as_tensor(a)))
    def _A_setup():
        B, S, D = 1, 2048, 1024
        ks = 4
        return {
            "q": _w((lambda *s: torch.randn(*s, dtype=torch.bfloat16) * 0.05)(B, S, D)),
            "k": _w((lambda *s: torch.randn(*s, dtype=torch.bfloat16) * 0.8)(B, S, D)),
            "v": _w((lambda *s: torch.randn(*s, dtype=torch.bfloat16) * 0.8)(B, S, D)),
            "shift_k": _w((lambda *s: torch.randn(*s, dtype=torch.bfloat16) * 0.8)(D, ks) * 0.5),
            "ssm_k": _w((lambda *s: torch.randn(*s, dtype=torch.bfloat16) * 0.8)(D, S) * (1.0 / S ** 0.5)),
            "ssm_D": _w((lambda *s: torch.randn(*s, dtype=torch.bfloat16) * 0.8)(D)),
        }
    _A_in = _A_setup()

    def _B_setup():
        B, S, D, Dff = 1, 2048, 1024, 3584
        return {
            "x": _w((lambda *s: torch.randn(*s, dtype=torch.bfloat16) * 0.05)(B, S, D)),
            "w1": _w((lambda *s: torch.randn(*s, dtype=torch.bfloat16) * 0.05)(D, Dff)),
            "w2": _w((lambda *s: torch.randn(*s, dtype=torch.bfloat16) * 0.05)(Dff, D)),
        }
    _B_in = _B_setup()

    return {
        "A_q": _A_in["q"],
        "A_k": _A_in["k"],
        "A_v": _A_in["v"],
        "A_shift_k": _A_in["shift_k"],
        "A_ssm_k": _A_in["ssm_k"],
        "A_ssm_D": _A_in["ssm_D"],
        "B_x": _B_in["x"],
        "B_w1": _B_in["w1"],
        "B_w2": _B_in["w2"],
    }

def reference(A_q, A_k, A_v, A_shift_k, A_ssm_k, A_ssm_D, B_x, B_w1, B_w2):
    def _A_ref(q, k, v, shift_k, ssm_k, ssm_D):
        B, S, D = q.shape
        ks = shift_k.shape[-1]
        k_pad = _pad(k, ((0, 0), (ks - 1, 0), (0, 0)))
        k_shift = torch.zeros_like(k)
        for t in range(ks):
            k_shift = k_shift + k_pad[:, t:t + S, :] * shift_k[:, ks - 1 - t][None, None, :]
        kv = k_shift * v
        L = 2 * S
        kv_pad = _pad(kv, ((0, 0), (0, S), (0, 0)))
        kf_pad = _pad(ssm_k, ((0, 0), (0, S)))
        kv_f = (lambda x, axes=(-2,-1): torch.fft.rfft2(x.float(), dim=axes))(kv_pad[:, None, :, :], axes=(1, 2))
        kf_f = (lambda x, axes=(-2,-1): torch.fft.rfft2(x.float(), dim=axes))(kf_pad[:, None, :], axes=(1, 2))
        kf_f = (lambda x, *d: x.permute(*d))(kf_f, 1, 2, 0)
        y_f = kv_f * kf_f[None, :, :, :]
        y = (lambda x, s, axes=(-2,-1): torch.fft.irfft2(x, s=s, dim=axes).to(torch.bfloat16))(y_f, (1, L), axes=(1, 2))[:, 0, :S, :]
        y = y + kv * ssm_D[None, None, :]
        return q * y

    def _B_ref(x, w1, w2):
        h = torch.einsum("bsd,df->bsf", x, w1)
        zero = torch.zeros_like(h)
        h = torch.maximum(h, zero)
        return torch.einsum("bsf,fd->bsd", h, w2)

    x = A_q
    xn = _layernorm(x, axis=-1)
    return x + _A_ref(xn, A_k, A_v, A_shift_k, A_ssm_k, A_ssm_D) + _B_ref(xn, B_w1, B_w2)
```

```asm
; @launch grid=(256,1,1) block=(512,1,1) lds=163840
.amdgcn_target "amdgcn-amd-amdhsa--gfx950"
.text
.globl parallel_sum__ssm_conv_h3__dense_activation_relu__prompt_kernel
.p2align 8
.type parallel_sum__ssm_conv_h3__dense_activation_relu__prompt_kernel,@function
parallel_sum__ssm_conv_h3__dense_activation_relu__prompt_kernel:
s_cmp_ge_u32 s2, 256
s_cbranch_scc1 L_exit
s_load_dwordx8 s[4:11], s[0:1], 0
s_load_dwordx4 s[12:15], s[0:1], 32
s_load_dwordx8 s[16:23], s[0:1], 56
s_load_dwordx2 s[24:25], s[0:1], 88
v_and_b32 v1, 63, v0
v_lshrrev_b32 v2, 6, v0
s_nop 0
v_readfirstlane_b32 s32, v2
s_and_b32 s42, s2, 7
s_lshr_b32 s43, s2, 3
s_and_b32 s44, s42, 1
s_lshl_b32 s44, s44, 3
s_and_b32 s45, s43, 7
s_add_u32 s33, s44, s45
s_lshr_b32 s44, s42, 1
s_lshl_b32 s44, s44, 2
s_lshr_b32 s45, s43, 3
s_add_u32 s34, s44, s45
s_and_b32 s37, s42, 1
s_bfe_u32 s44, s42, 0x10001
s_lshl_b32 s44, s44, 3
s_and_b32 s45, s43, 7
s_add_u32 s35, s44, s45
s_lshr_b32 s44, s42, 2
s_lshl_b32 s44, s44, 2
s_lshr_b32 s45, s43, 3
s_add_u32 s36, s44, s45
s_lshr_b32 s44, s36, 1
s_and_b32 s45, s36, 1
s_lshl_b32 s96, s44, 2
s_bitcmp1_b32 s44, 0
s_cselect_b32 s46, 1, 0
s_lshl_b32 s45, s45, s46
s_add_u32 s96, s96, s45
s_sub_u32 s46, 2, s46
s_add_u32 s97, s96, s46
s_cmp_eq_u32 s37, 0
s_cselect_b32 s95, s96, s97
s_and_b32 s38, s32, 3
s_and_b32 s83, s38, 1
s_lshr_b32 s84, s38, 1
s_waitcnt lgkmcnt(0)
s_mov_b32 s28, s24
s_mov_b32 s29, s25
s_mov_b32 s30, 50331648
s_mov_b32 s31, 0x20000
s_cmp_ge_u32 s32, 4
s_cbranch_scc1 L_roleH
s_mov_b32 s64, s22
s_mov_b32 s65, s23
s_mov_b32 s66, 256
s_mov_b32 s67, 0x20000
v_mov_b32 v78, 0
s_cmp_lg_u32 s38, 3
s_cbranch_scc1 L_only_1
s_memrealtime s[90:91]
s_waitcnt lgkmcnt(0)
s_cmp_lg_u32 s2, 0
s_cbranch_scc1 L_np_2
s_or_b32 s48, s90, 1
v_mov_b32 v76, s48
v_mov_b32 v77, s91
s_mov_b64 exec, 1
buffer_store_dwordx2 v[76:77], v78, s[64:67], 0 offen sc1
s_mov_b64 exec, -1
L_np_2:
L_only_1:
s_mov_b32 s60, s4
s_mov_b32 s61, s5
s_mov_b32 s62, 4194304
s_mov_b32 s63, 0x20000
v_and_b32 v3, 3, v1
v_bfe_u32 v4, v1, 2, 1
v_lshrrev_b32 v5, 3, v1
v_lshlrev_b32 v6, 4, v3
v_lshlrev_b32 v7, 11, v4
v_lshlrev_b32 v8, 6, v5
v_add3_u32 v2, v6, v7, v8
s_lshl_b32 s42, s33, 7
s_lshl_b32 s43, s34, 3
s_add_u32 s42, s42, s43
s_lshl_b32 s43, s38, 1
s_add_u32 s42, s42, s43
s_lshl_b32 s42, s42, 11
buffer_load_dwordx4 v[16:19], v2, s[60:63], s42 offen offset:0
buffer_load_dwordx4 v[20:23], v2, s[60:63], s42 offen offset:512
buffer_load_dwordx4 v[24:27], v2, s[60:63], s42 offen offset:1024
buffer_load_dwordx4 v[28:31], v2, s[60:63], s42 offen offset:1536
s_cmp_lg_u32 s38, 3
s_cbranch_scc1 L_only_3
buffer_load_dwordx2 v[76:77], v78, s[64:67], 0 offen sc1
L_only_3:
s_mov_b32 s64, s6
s_mov_b32 s65, s7
s_mov_b32 s66, 4194304
s_mov_b32 s67, 0x20000
s_mov_b32 s72, s10
s_mov_b32 s73, s11
s_mov_b32 s74, 8192
s_mov_b32 s75, 0x20000
v_and_b32 v9, 7, v1
v_lshrrev_b32 v10, 3, v1
s_lshl_b32 s43, s38, 3
v_add_u32 v10, s43, v10
v_lshlrev_b32 v11, 13, v10
v_lshlrev_b32 v12, 4, v9
v_add_u32 v11, v11, v12
s_lshl_b32 s43, s33, 18
s_lshl_b32 s44, s34, 7
s_add_u32 s43, s43, s44
s_sub_u32 s43, s43, 6144
v_add_u32 v11, s43, v11
v_add_u32 v13, 0x1800, v11
buffer_load_dwordx4 v[128:131], v11, s[64:67], 0 offen nt
v_add_u32 v11, 0x800, v11
buffer_load_dwordx4 v[132:135], v11, s[64:67], 0 offen nt
v_add_u32 v11, 0x800, v11
buffer_load_dwordx4 v[136:139], v11, s[64:67], 0 offen nt
v_add_u32 v11, 0x800, v11
buffer_load_dwordx4 v[140:143], v11, s[64:67], 0 offen nt
v_add_u32 v11, 0x800, v11
buffer_load_dwordx4 v[144:147], v11, s[64:67], 0 offen nt
v_add_u32 v11, 0x800, v11
buffer_load_dwordx4 v[148:151], v11, s[64:67], 0 offen nt
v_add_u32 v11, 0x800, v11
buffer_load_dwordx4 v[152:155], v11, s[64:67], 0 offen nt
v_lshlrev_b32 v12, 6, v9
s_lshl_b32 s43, s34, 9
buffer_load_dwordx4 v[172:175], v12, s[72:75], s43 offen offset:0
buffer_load_dwordx4 v[176:179], v12, s[72:75], s43 offen offset:16
buffer_load_dwordx4 v[180:183], v12, s[72:75], s43 offen offset:32
buffer_load_dwordx4 v[184:187], v12, s[72:75], s43 offen offset:48
s_mov_b32 s68, s8
s_mov_b32 s69, s9
s_mov_b32 s70, 4194304
s_mov_b32 s71, 0x20000
buffer_load_dwordx4 v[156:159], v13, s[68:71], 0 offen nt
v_add_u32 v13, 0x800, v13
buffer_load_dwordx4 v[160:163], v13, s[68:71], 0 offen nt
v_add_u32 v13, 0x800, v13
buffer_load_dwordx4 v[164:167], v13, s[68:71], 0 offen nt
v_add_u32 v13, 0x800, v13
buffer_load_dwordx4 v[168:171], v13, s[68:71], 0 offen nt
s_barrier
s_waitcnt vmcnt(15)
v_lshlrev_b32 v32, 16, v16
v_and_b32 v33, 0xffff0000, v16
v_lshlrev_b32 v34, 16, v17
v_and_b32 v35, 0xffff0000, v17
v_lshlrev_b32 v36, 16, v18
v_and_b32 v37, 0xffff0000, v18
v_lshlrev_b32 v38, 16, v19
v_and_b32 v39, 0xffff0000, v19
v_lshlrev_b32 v40, 16, v20
v_and_b32 v41, 0xffff0000, v20
v_lshlrev_b32 v42, 16, v21
v_and_b32 v43, 0xffff0000, v21
v_lshlrev_b32 v44, 16, v22
v_and_b32 v45, 0xffff0000, v22
v_lshlrev_b32 v46, 16, v23
v_and_b32 v47, 0xffff0000, v23
v_lshlrev_b32 v48, 16, v24
v_and_b32 v49, 0xffff0000, v24
v_lshlrev_b32 v50, 16, v25
v_and_b32 v51, 0xffff0000, v25
v_lshlrev_b32 v52, 16, v26
v_and_b32 v53, 0xffff0000, v26
v_lshlrev_b32 v54, 16, v27
v_and_b32 v55, 0xffff0000, v27
v_lshlrev_b32 v56, 16, v28
v_and_b32 v57, 0xffff0000, v28
v_lshlrev_b32 v58, 16, v29
v_and_b32 v59, 0xffff0000, v29
v_lshlrev_b32 v60, 16, v30
v_and_b32 v61, 0xffff0000, v30
v_lshlrev_b32 v62, 16, v31
v_and_b32 v63, 0xffff0000, v31
v_pk_add_f32 v[64:65], v[32:33], v[34:35]
v_pk_add_f32 v[66:67], v[36:37], v[38:39]
v_pk_add_f32 v[64:65], v[64:65], v[40:41]
v_pk_add_f32 v[66:67], v[66:67], v[42:43]
v_pk_add_f32 v[64:65], v[64:65], v[44:45]
v_pk_add_f32 v[66:67], v[66:67], v[46:47]
v_pk_add_f32 v[64:65], v[64:65], v[48:49]
v_pk_add_f32 v[66:67], v[66:67], v[50:51]
v_pk_add_f32 v[64:65], v[64:65], v[52:53]
v_pk_add_f32 v[66:67], v[66:67], v[54:55]
v_pk_add_f32 v[64:65], v[64:65], v[56:57]
v_pk_add_f32 v[66:67], v[66:67], v[58:59]
v_pk_add_f32 v[64:65], v[64:65], v[60:61]
v_pk_add_f32 v[66:67], v[66:67], v[62:63]
v_pk_add_f32 v[64:65], v[64:65], v[66:67]
v_add_f32 v64, v64, v65
s_nop 1
v_add_f32_dpp v64, v64, v64 quad_perm:[1,0,3,2] row_mask:0xf bank_mask:0xf
s_nop 1
v_add_f32_dpp v64, v64, v64 quad_perm:[2,3,0,1] row_mask:0xf bank_mask:0xf
s_nop 1
v_add_f32_dpp v64, v64, v64 row_ror:8 row_mask:0xf bank_mask:0xf
v_mov_b32 v65, v64
s_nop 1
v_permlane16_swap_b32 v64, v65
v_add_f32 v64, v64, v65
v_mov_b32 v65, v64
s_nop 1
v_permlane32_swap_b32 v64, v65
v_add_f32 v64, v64, v65
v_mul_f32 v64, 0x3a800000, v64
v_sub_f32 v66, 0, v64
v_mov_b32 v67, v66
v_mov_b32 v68, 0
v_mov_b32 v69, 0
v_mov_b32 v70, 0
v_mov_b32 v71, 0
v_pk_add_f32 v[72:73], v[32:33], v[66:67]
v_pk_add_f32 v[74:75], v[34:35], v[66:67]
v_pk_fma_f32 v[68:69], v[72:73], v[72:73], v[68:69]
v_pk_fma_f32 v[70:71], v[74:75], v[74:75], v[70:71]
v_pk_add_f32 v[72:73], v[36:37], v[66:67]
v_pk_add_f32 v[74:75], v[38:39], v[66:67]
v_pk_fma_f32 v[68:69], v[72:73], v[72:73], v[68:69]
v_pk_fma_f32 v[70:71], v[74:75], v[74:75], v[70:71]
v_pk_add_f32 v[72:73], v[40:41], v[66:67]
v_pk_add_f32 v[74:75], v[42:43], v[66:67]
v_pk_fma_f32 v[68:69], v[72:73], v[72:73], v[68:69]
v_pk_fma_f32 v[70:71], v[74:75], v[74:75], v[70:71]
v_pk_add_f32 v[72:73], v[44:45], v[66:67]
v_pk_add_f32 v[74:75], v[46:47], v[66:67]
v_pk_fma_f32 v[68:69], v[72:73], v[72:73], v[68:69]
v_pk_fma_f32 v[70:71], v[74:75], v[74:75], v[70:71]
v_pk_add_f32 v[72:73], v[48:49], v[66:67]
v_pk_add_f32 v[74:75], v[50:51], v[66:67]
v_pk_fma_f32 v[68:69], v[72:73], v[72:73], v[68:69]
v_pk_fma_f32 v[70:71], v[74:75], v[74:75], v[70:71]
v_pk_add_f32 v[72:73], v[52:53], v[66:67]
v_pk_add_f32 v[74:75], v[54:55], v[66:67]
v_pk_fma_f32 v[68:69], v[72:73], v[72:73], v[68:69]
v_pk_fma_f32 v[70:71], v[74:75], v[74:75], v[70:71]
v_pk_add_f32 v[72:73], v[56:57], v[66:67]
v_pk_add_f32 v[74:75], v[58:59], v[66:67]
v_pk_fma_f32 v[68:69], v[72:73], v[72:73], v[68:69]
v_pk_fma_f32 v[70:71], v[74:75], v[74:75], v[70:71]
v_pk_add_f32 v[72:73], v[60:61], v[66:67]
v_pk_add_f32 v[74:75], v[62:63], v[66:67]
v_pk_fma_f32 v[68:69], v[72:73], v[72:73], v[68:69]
v_pk_fma_f32 v[70:71], v[74:75], v[74:75], v[70:71]
v_pk_add_f32 v[68:69], v[68:69], v[70:71]
v_add_f32 v68, v68, v69
s_nop 1
v_add_f32_dpp v68, v68, v68 quad_perm:[1,0,3,2] row_mask:0xf bank_mask:0xf
s_nop 1
v_add_f32_dpp v68, v68, v68 quad_perm:[2,3,0,1] row_mask:0xf bank_mask:0xf
s_nop 1
v_add_f32_dpp v68, v68, v68 row_ror:8 row_mask:0xf bank_mask:0xf
v_mov_b32 v69, v68
s_nop 1
v_permlane16_swap_b32 v68, v69
v_add_f32 v68, v68, v69
v_mov_b32 v69, v68
s_nop 1
v_permlane32_swap_b32 v68, v69
v_add_f32 v68, v68, v69
v_mul_f32 v68, 0x3a800000, v68
v_cvt_pk_bf16_f32 v68, v68, v68
v_lshlrev_b32 v68, 16, v68
v_add_f32 v68, 0x3727c5ac, v68
v_cvt_pk_bf16_f32 v68, v68, v68
v_lshlrev_b32 v68, 16, v68
v_sqrt_f32 v68, v68
s_nop 0
v_cvt_pk_bf16_f32 v68, v68, v68
v_lshlrev_b32 v68, 16, v68
v_rcp_f32 v68, v68
v_cvt_pk_bf16_f32 v64, v64, v64
v_lshlrev_b32 v64, 16, v64
v_sub_f32 v66, 0, v64
v_mov_b32 v67, v66
v_mov_b32 v69, v68
v_pk_add_f32 v[72:73], v[32:33], v[66:67]
v_cvt_pk_bf16_f32 v72, v72, v73
v_and_b32 v73, 0xffff0000, v72
v_lshlrev_b32 v72, 16, v72
v_pk_mul_f32 v[72:73], v[72:73], v[68:69]
v_cvt_pk_bf16_f32 v16, v72, v73
v_pk_add_f32 v[74:75], v[34:35], v[66:67]
v_cvt_pk_bf16_f32 v74, v74, v75
v_and_b32 v75, 0xffff0000, v74
v_lshlrev_b32 v74, 16, v74
v_pk_mul_f32 v[74:75], v[74:75], v[68:69]
v_cvt_pk_bf16_f32 v17, v74, v75
v_pk_add_f32 v[72:73], v[36:37], v[66:67]
v_cvt_pk_bf16_f32 v72, v72, v73
v_and_b32 v73, 0xffff0000, v72
v_lshlrev_b32 v72, 16, v72
v_pk_mul_f32 v[72:73], v[72:73], v[68:69]
v_cvt_pk_bf16_f32 v18, v72, v73
v_pk_add_f32 v[74:75], v[38:39], v[66:67]
v_cvt_pk_bf16_f32 v74, v74, v75
v_and_b32 v75, 0xffff0000, v74
v_lshlrev_b32 v74, 16, v74
v_pk_mul_f32 v[74:75], v[74:75], v[68:69]
v_cvt_pk_bf16_f32 v19, v74, v75
v_pk_add_f32 v[72:73], v[40:41], v[66:67]
v_cvt_pk_bf16_f32 v72, v72, v73
v_and_b32 v73, 0xffff0000, v72
v_lshlrev_b32 v72, 16, v72
v_pk_mul_f32 v[72:73], v[72:73], v[68:69]
v_cvt_pk_bf16_f32 v20, v72, v73
v_pk_add_f32 v[74:75], v[42:43], v[66:67]
v_cvt_pk_bf16_f32 v74, v74, v75
v_and_b32 v75, 0xffff0000, v74
v_lshlrev_b32 v74, 16, v74
v_pk_mul_f32 v[74:75], v[74:75], v[68:69]
v_cvt_pk_bf16_f32 v21, v74, v75
v_pk_add_f32 v[72:73], v[44:45], v[66:67]
v_cvt_pk_bf16_f32 v72, v72, v73
v_and_b32 v73, 0xffff0000, v72
v_lshlrev_b32 v72, 16, v72
v_pk_mul_f32 v[72:73], v[72:73], v[68:69]
v_cvt_pk_bf16_f32 v22, v72, v73
v_pk_add_f32 v[74:75], v[46:47], v[66:67]
v_cvt_pk_bf16_f32 v74, v74, v75
v_and_b32 v75, 0xffff0000, v74
v_lshlrev_b32 v74, 16, v74
v_pk_mul_f32 v[74:75], v[74:75], v[68:69]
v_cvt_pk_bf16_f32 v23, v74, v75
v_pk_add_f32 v[72:73], v[48:49], v[66:67]
v_cvt_pk_bf16_f32 v72, v72, v73
v_and_b32 v73, 0xffff0000, v72
v_lshlrev_b32 v72, 16, v72
v_pk_mul_f32 v[72:73], v[72:73], v[68:69]
v_cvt_pk_bf16_f32 v24, v72, v73
v_pk_add_f32 v[74:75], v[50:51], v[66:67]
v_cvt_pk_bf16_f32 v74, v74, v75
v_and_b32 v75, 0xffff0000, v74
v_lshlrev_b32 v74, 16, v74
v_pk_mul_f32 v[74:75], v[74:75], v[68:69]
v_cvt_pk_bf16_f32 v25, v74, v75
v_pk_add_f32 v[72:73], v[52:53], v[66:67]
v_cvt_pk_bf16_f32 v72, v72, v73
v_and_b32 v73, 0xffff0000, v72
v_lshlrev_b32 v72, 16, v72
v_pk_mul_f32 v[72:73], v[72:73], v[68:69]
v_cvt_pk_bf16_f32 v26, v72, v73
v_pk_add_f32 v[74:75], v[54:55], v[66:67]
v_cvt_pk_bf16_f32 v74, v74, v75
v_and_b32 v75, 0xffff0000, v74
v_lshlrev_b32 v74, 16, v74
v_pk_mul_f32 v[74:75], v[74:75], v[68:69]
v_cvt_pk_bf16_f32 v27, v74, v75
v_pk_add_f32 v[72:73], v[56:57], v[66:67]
v_cvt_pk_bf16_f32 v72, v72, v73
v_and_b32 v73, 0xffff0000, v72
v_lshlrev_b32 v72, 16, v72
v_pk_mul_f32 v[72:73], v[72:73], v[68:69]
v_cvt_pk_bf16_f32 v28, v72, v73
v_pk_add_f32 v[74:75], v[58:59], v[66:67]
v_cvt_pk_bf16_f32 v74, v74, v75
v_and_b32 v75, 0xffff0000, v74
v_lshlrev_b32 v74, 16, v74
v_pk_mul_f32 v[74:75], v[74:75], v[68:69]
v_cvt_pk_bf16_f32 v29, v74, v75
v_pk_add_f32 v[72:73], v[60:61], v[66:67]
v_cvt_pk_bf16_f32 v72, v72, v73
v_and_b32 v73, 0xffff0000, v72
v_lshlrev_b32 v72, 16, v72
v_pk_mul_f32 v[72:73], v[72:73], v[68:69]
v_cvt_pk_bf16_f32 v30, v72, v73
v_pk_add_f32 v[74:75], v[62:63], v[66:67]
v_cvt_pk_bf16_f32 v74, v74, v75
v_and_b32 v75, 0xffff0000, v74
v_lshlrev_b32 v74, 16, v74
v_pk_mul_f32 v[74:75], v[74:75], v[68:69]
v_cvt_pk_bf16_f32 v31, v74, v75
s_lshl_b32 s42, s34, 1
s_lshr_b32 s43, s38, 1
s_add_u32 s42, s42, s43
s_sub_u32 s42, 0, s42
s_and_b32 s42, s42, 3
v_xor_b32 v3, s42, v3
v_lshlrev_b32 v3, 4, v3
v_lshlrev_b32 v4, 6, v4
v_lshlrev_b32 v5, 13, v5
v_add3_u32 v2, v3, v4, v5
s_lshl_b32 s42, s33, 18
s_lshl_b32 s43, s34, 9
s_add_u32 s42, s42, s43
s_lshl_b32 s43, s38, 7
s_add_u32 s42, s42, s43
buffer_store_dwordx4 v[16:19], v2, s[28:31], s42 offen sc1
s_add_u32 s42, s42, 65536
buffer_store_dwordx4 v[20:23], v2, s[28:31], s42 offen sc1
s_add_u32 s42, s42, 65536
buffer_store_dwordx4 v[24:27], v2, s[28:31], s42 offen sc1
s_add_u32 s42, s42, 65536
buffer_store_dwordx4 v[28:31], v2, s[28:31], s42 offen sc1
s_mov_b32 s60, s22
s_mov_b32 s61, s23
s_mov_b32 s62, 256
s_mov_b32 s63, 0x20000
s_cmp_lg_u32 s38, 3
s_cbranch_scc1 L_only_4
s_mov_b32 s85, 20000
s_mov_b32 s48, 0
L_non:
v_readfirstlane_b32 s40, v76
v_readfirstlane_b32 s41, v77
s_nop 2
s_cmp_lg_u32 s40, 0
s_cbranch_scc1 L_nonz
s_mov_b32 s48, 1
s_branch L_nonw
L_nonz:
s_cmp_eq_u32 s48, 1
s_cbranch_scc1 L_nond
s_sub_u32 s49, s90, s40
s_cmp_lt_i32 s49, 1500
s_cbranch_scc1 L_nond
L_nonw:
s_sub_u32 s85, s85, 1
s_cmp_eq_u32 s85, 0
s_cbranch_scc1 L_nond
buffer_load_dwordx2 v[76:77], v78, s[60:63], 0 offen sc1
s_waitcnt vmcnt(0)
s_branch L_non
L_nond:
s_or_b32 s40, s40, 1
v_mov_b32 v76, s40
v_mov_b32 v77, s41
v_mov_b32 v79, 155648
ds_write_b64 v79, v[76:77]
L_only_4:
s_waitcnt vmcnt(4)
v_lshlrev_b32 v188, 16, v172
v_and_b32 v196, 0xffff0000, v172
v_lshlrev_b32 v204, 16, v173
v_and_b32 v212, 0xffff0000, v173
v_lshlrev_b32 v189, 16, v174
v_and_b32 v197, 0xffff0000, v174
v_lshlrev_b32 v205, 16, v175
v_and_b32 v213, 0xffff0000, v175
v_lshlrev_b32 v190, 16, v176
v_and_b32 v198, 0xffff0000, v176
v_lshlrev_b32 v206, 16, v177
v_and_b32 v214, 0xffff0000, v177
v_lshlrev_b32 v191, 16, v178
v_and_b32 v199, 0xffff0000, v178
v_lshlrev_b32 v207, 16, v179
v_and_b32 v215, 0xffff0000, v179
v_lshlrev_b32 v192, 16, v180
v_and_b32 v200, 0xffff0000, v180
v_lshlrev_b32 v208, 16, v181
v_and_b32 v216, 0xffff0000, v181
v_lshlrev_b32 v193, 16, v182
v_and_b32 v201, 0xffff0000, v182
v_lshlrev_b32 v209, 16, v183
v_and_b32 v217, 0xffff0000, v183
v_lshlrev_b32 v194, 16, v184
v_and_b32 v202, 0xffff0000, v184
v_lshlrev_b32 v210, 16, v185
v_and_b32 v218, 0xffff0000, v185
v_lshlrev_b32 v195, 16, v186
v_and_b32 v203, 0xffff0000, v186
v_lshlrev_b32 v211, 16, v187
v_and_b32 v219, 0xffff0000, v187
v_sub_u32 v12, 31, v10
v_lshrrev_b32 v13, 1, v12
v_xor_b32 v13, v13, v9
v_lshlrev_b32 v13, 4, v13
v_and_b32 v12, 1, v12
v_lshlrev_b32 v12, 3, v12
v_lshlrev_b32 v14, 11, v9
v_add3_u32 v12, v12, v13, v14
v_add_u32 v12, 135168, v12
v_lshlrev_b32 v32, 16, v128
v_and_b32 v33, 0xffff0000, v128
v_lshlrev_b32 v34, 16, v132
v_and_b32 v35, 0xffff0000, v132
v_lshlrev_b32 v36, 16, v136
v_and_b32 v37, 0xffff0000, v136
v_lshlrev_b32 v38, 16, v140
v_and_b32 v39, 0xffff0000, v140
v_lshlrev_b32 v40, 16, v144
v_and_b32 v41, 0xffff0000, v144
v_lshlrev_b32 v42, 16, v148
v_and_b32 v43, 0xffff0000, v148
v_lshlrev_b32 v44, 16, v152
v_and_b32 v45, 0xffff0000, v152
v_lshlrev_b32 v46, 16, v156
v_and_b32 v47, 0xffff0000, v156
v_lshlrev_b32 v48, 16, v160
v_and_b32 v49, 0xffff0000, v160
v_lshlrev_b32 v50, 16, v164
v_and_b32 v51, 0xffff0000, v164
v_lshlrev_b32 v52, 16, v168
v_and_b32 v53, 0xffff0000, v168
v_pk_mul_f32 v[54:55], v[38:39], v[188:189]
v_pk_mul_f32 v[56:57], v[40:41], v[188:189]
v_pk_mul_f32 v[58:59], v[42:43], v[188:189]
v_pk_mul_f32 v[60:61], v[44:45], v[188:189]
v_pk_fma_f32 v[54:55], v[36:37], v[196:197], v[54:55]
v_pk_fma_f32 v[56:57], v[38:39], v[196:197], v[56:57]
v_pk_fma_f32 v[58:59], v[40:41], v[196:197], v[58:59]
v_pk_fma_f32 v[60:61], v[42:43], v[196:197], v[60:61]
v_pk_fma_f32 v[54:55], v[34:35], v[204:205], v[54:55]
v_pk_fma_f32 v[56:57], v[36:37], v[204:205], v[56:57]
v_pk_fma_f32 v[58:59], v[38:39], v[204:205], v[58:59]
v_pk_fma_f32 v[60:61], v[40:41], v[204:205], v[60:61]
v_pk_fma_f32 v[54:55], v[32:33], v[212:213], v[54:55]
v_pk_fma_f32 v[56:57], v[34:35], v[212:213], v[56:57]
v_pk_fma_f32 v[58:59], v[36:37], v[212:213], v[58:59]
v_pk_fma_f32 v[60:61], v[38:39], v[212:213], v[60:61]
v_pk_mul_f32 v[54:55], v[54:55], v[46:47]
v_pk_mul_f32 v[56:57], v[56:57], v[48:49]
v_pk_mul_f32 v[58:59], v[58:59], v[50:51]
v_pk_mul_f32 v[60:61], v[60:61], v[52:53]
v_cvt_pk_bf16_f32 v62, v60, v58
v_cvt_pk_bf16_f32 v63, v56, v54
ds_write_b64 v12, v[62:63] offset:0
v_cvt_pk_bf16_f32 v64, v61, v59
v_cvt_pk_bf16_f32 v65, v57, v55
ds_write_b64 v12, v[64:65] offset:256
s_waitcnt vmcnt(0)
s_waitcnt lgkmcnt(0)
v_mov_b32 v79, 155664
v_mov_b32 v80, 1
s_mov_b64 exec, 1
ds_add_rtn_u32 v81, v79, v80
s_mov_b64 exec, -1
s_waitcnt lgkmcnt(0)
v_readfirstlane_b32 s42, v81
s_nop 3
s_cmp_lg_u32 s42, 3
s_cbranch_scc1 L_sk_5
v_mov_b32 v84, 155648
s_mov_b32 s85, 160000
L_gn_6:
ds_read_b64 v[82:83], v84
s_waitcnt lgkmcnt(0)
v_readfirstlane_b32 s40, v82
v_readfirstlane_b32 s41, v83
s_nop 2
s_cmp_lg_u32 s40, 0
s_cbranch_scc1 L_gnd_7
s_sub_u32 s85, s85, 1
s_cmp_eq_u32 s85, 0
s_cbranch_scc1 L_gnd_7
s_sleep 1
s_branch L_gn_6
L_gnd_7:
s_lshl_b32 s42, s33, 7
s_lshl_b32 s43, s34, 3
s_add_u32 s42, s42, s43
s_add_u32 s42, s42, 41943040
v_mov_b32 v82, s40
v_mov_b32 v83, s41
v_mov_b32 v84, 0
s_mov_b64 exec, 1
buffer_store_dwordx2 v[82:83], v84, s[28:31], s42 offen sc1
s_mov_b64 exec, -1
v_mov_b32 v79, 155672
s_mov_b64 exec, 1
ds_add_u32 v79, v80
s_mov_b64 exec, -1
L_sk_5:
v_lshlrev_b32 v32, 16, v129
v_and_b32 v33, 0xffff0000, v129
v_lshlrev_b32 v34, 16, v133
v_and_b32 v35, 0xffff0000, v133
v_lshlrev_b32 v36, 16, v137
v_and_b32 v37, 0xffff0000, v137
v_lshlrev_b32 v38, 16, v141
v_and_b32 v39, 0xffff0000, v141
v_lshlrev_b32 v40, 16, v145
v_and_b32 v41, 0xffff0000, v145
v_lshlrev_b32 v42, 16, v149
v_and_b32 v43, 0xffff0000, v149
v_lshlrev_b32 v44, 16, v153
v_and_b32 v45, 0xffff0000, v153
v_lshlrev_b32 v46, 16, v157
v_and_b32 v47, 0xffff0000, v157
v_lshlrev_b32 v48, 16, v161
v_and_b32 v49, 0xffff0000, v161
v_lshlrev_b32 v50, 16, v165
v_and_b32 v51, 0xffff0000, v165
v_lshlrev_b32 v52, 16, v169
v_and_b32 v53, 0xffff0000, v169
v_pk_mul_f32 v[54:55], v[38:39], v[190:191]
v_pk_mul_f32 v[56:57], v[40:41], v[190:191]
v_pk_mul_f32 v[58:59], v[42:43], v[190:191]
v_pk_mul_f32 v[60:61], v[44:45], v[190:191]
v_pk_fma_f32 v[54:55], v[36:37], v[198:199], v[54:55]
v_pk_fma_f32 v[56:57], v[38:39], v[198:199], v[56:57]
v_pk_fma_f32 v[58:59], v[40:41], v[198:199], v[58:59]
v_pk_fma_f32 v[60:61], v[42:43], v[198:199], v[60:61]
v_pk_fma_f32 v[54:55], v[34:35], v[206:207], v[54:55]
v_pk_fma_f32 v[56:57], v[36:37], v[206:207], v[56:57]
v_pk_fma_f32 v[58:59], v[38:39], v[206:207], v[58:59]
v_pk_fma_f32 v[60:61], v[40:41], v[206:207], v[60:61]
v_pk_fma_f32 v[54:55], v[32:33], v[214:215], v[54:55]
v_pk_fma_f32 v[56:57], v[34:35], v[214:215], v[56:57]
v_pk_fma_f32 v[58:59], v[36:37], v[214:215], v[58:59]
v_pk_fma_f32 v[60:61], v[38:39], v[214:215], v[60:61]
v_pk_mul_f32 v[54:55], v[54:55], v[46:47]
v_pk_mul_f32 v[56:57], v[56:57], v[48:49]
v_pk_mul_f32 v[58:59], v[58:59], v[50:51]
v_pk_mul_f32 v[60:61], v[60:61], v[52:53]
v_cvt_pk_bf16_f32 v66, v60, v58
v_cvt_pk_bf16_f32 v67, v56, v54
ds_write_b64 v12, v[66:67] offset:512
v_cvt_pk_bf16_f32 v68, v61, v59
v_cvt_pk_bf16_f32 v69, v57, v55
ds_write_b64 v12, v[68:69] offset:768
v_lshlrev_b32 v32, 16, v130
v_and_b32 v33, 0xffff0000, v130
v_lshlrev_b32 v34, 16, v134
v_and_b32 v35, 0xffff0000, v134
v_lshlrev_b32 v36, 16, v138
v_and_b32 v37, 0xffff0000, v138
v_lshlrev_b32 v38, 16, v142
v_and_b32 v39, 0xffff0000, v142
v_lshlrev_b32 v40, 16, v146
v_and_b32 v41, 0xffff0000, v146
v_lshlrev_b32 v42, 16, v150
v_and_b32 v43, 0xffff0000, v150
v_lshlrev_b32 v44, 16, v154
v_and_b32 v45, 0xffff0000, v154
v_lshlrev_b32 v46, 16, v158
v_and_b32 v47, 0xffff0000, v158
v_lshlrev_b32 v48, 16, v162
v_and_b32 v49, 0xffff0000, v162
v_lshlrev_b32 v50, 16, v166
v_and_b32 v51, 0xffff0000, v166
v_lshlrev_b32 v52, 16, v170
v_and_b32 v53, 0xffff0000, v170
v_pk_mul_f32 v[54:55], v[38:39], v[192:193]
v_pk_mul_f32 v[56:57], v[40:41], v[192:193]
v_pk_mul_f32 v[58:59], v[42:43], v[192:193]
v_pk_mul_f32 v[60:61], v[44:45], v[192:193]
v_pk_fma_f32 v[54:55], v[36:37], v[200:201], v[54:55]
v_pk_fma_f32 v[56:57], v[38:39], v[200:201], v[56:57]
v_pk_fma_f32 v[58:59], v[40:41], v[200:201], v[58:59]
v_pk_fma_f32 v[60:61], v[42:43], v[200:201], v[60:61]
v_pk_fma_f32 v[54:55], v[34:35], v[208:209], v[54:55]
v_pk_fma_f32 v[56:57], v[36:37], v[208:209], v[56:57]
v_pk_fma_f32 v[58:59], v[38:39], v[208:209], v[58:59]
v_pk_fma_f32 v[60:61], v[40:41], v[208:209], v[60:61]
v_pk_fma_f32 v[54:55], v[32:33], v[216:217], v[54:55]
v_pk_fma_f32 v[56:57], v[34:35], v[216:217], v[56:57]
v_pk_fma_f32 v[58:59], v[36:37], v[216:217], v[58:59]
v_pk_fma_f32 v[60:61], v[38:39], v[216:217], v[60:61]
v_pk_mul_f32 v[54:55], v[54:55], v[46:47]
v_pk_mul_f32 v[56:57], v[56:57], v[48:49]
v_pk_mul_f32 v[58:59], v[58:59], v[50:51]
v_pk_mul_f32 v[60:61], v[60:61], v[52:53]
v_cvt_pk_bf16_f32 v62, v60, v58
v_cvt_pk_bf16_f32 v63, v56, v54
ds_write_b64 v12, v[62:63] offset:1024
v_cvt_pk_bf16_f32 v64, v61, v59
v_cvt_pk_bf16_f32 v65, v57, v55
ds_write_b64 v12, v[64:65] offset:1280
v_lshlrev_b32 v32, 16, v131
v_and_b32 v33, 0xffff0000, v131
v_lshlrev_b32 v34, 16, v135
v_and_b32 v35, 0xffff0000, v135
v_lshlrev_b32 v36, 16, v139
v_and_b32 v37, 0xffff0000, v139
v_lshlrev_b32 v38, 16, v143
v_and_b32 v39, 0xffff0000, v143
v_lshlrev_b32 v40, 16, v147
v_and_b32 v41, 0xffff0000, v147
v_lshlrev_b32 v42, 16, v151
v_and_b32 v43, 0xffff0000, v151
v_lshlrev_b32 v44, 16, v155
v_and_b32 v45, 0xffff0000, v155
v_lshlrev_b32 v46, 16, v159
v_and_b32 v47, 0xffff0000, v159
v_lshlrev_b32 v48, 16, v163
v_and_b32 v49, 0xffff0000, v163
v_lshlrev_b32 v50, 16, v167
v_and_b32 v51, 0xffff0000, v167
v_lshlrev_b32 v52, 16, v171
v_and_b32 v53, 0xffff0000, v171
v_pk_mul_f32 v[54:55], v[38:39], v[194:195]
v_pk_mul_f32 v[56:57], v[40:41], v[194:195]
v_pk_mul_f32 v[58:59], v[42:43], v[194:195]
v_pk_mul_f32 v[60:61], v[44:45], v[194:195]
v_pk_fma_f32 v[54:55], v[36:37], v[202:203], v[54:55]
v_pk_fma_f32 v[56:57], v[38:39], v[202:203], v[56:57]
v_pk_fma_f32 v[58:59], v[40:41], v[202:203], v[58:59]
v_pk_fma_f32 v[60:61], v[42:43], v[202:203], v[60:61]
v_pk_fma_f32 v[54:55], v[34:35], v[210:211], v[54:55]
v_pk_fma_f32 v[56:57], v[36:37], v[210:211], v[56:57]
v_pk_fma_f32 v[58:59], v[38:39], v[210:211], v[58:59]
v_pk_fma_f32 v[60:61], v[40:41], v[210:211], v[60:61]
v_pk_fma_f32 v[54:55], v[32:33], v[218:219], v[54:55]
v_pk_fma_f32 v[56:57], v[34:35], v[218:219], v[56:57]
v_pk_fma_f32 v[58:59], v[36:37], v[218:219], v[58:59]
v_pk_fma_f32 v[60:61], v[38:39], v[218:219], v[60:61]
v_pk_mul_f32 v[54:55], v[54:55], v[46:47]
v_pk_mul_f32 v[56:57], v[56:57], v[48:49]
v_pk_mul_f32 v[58:59], v[58:59], v[50:51]
v_pk_mul_f32 v[60:61], v[60:61], v[52:53]
v_cvt_pk_bf16_f32 v66, v60, v58
v_cvt_pk_bf16_f32 v67, v56, v54
ds_write_b64 v12, v[66:67] offset:1536
v_cvt_pk_bf16_f32 v68, v61, v59
v_cvt_pk_bf16_f32 v69, v57, v55
ds_write_b64 v12, v[68:69] offset:1792
s_waitcnt lgkmcnt(0)
v_mov_b32 v79, 155668
v_mov_b32 v80, 1
s_mov_b64 exec, 1
ds_add_u32 v79, v80
s_mov_b64 exec, -1
s_mov_b32 s85, 20000
L_cnt_8:
ds_read_b32 v81, v79
s_waitcnt lgkmcnt(0)
v_readfirstlane_b32 s42, v81
s_nop 3
s_cmp_ge_u32 s42, 4
s_cbranch_scc1 L_cntd_9
s_sub_u32 s85, s85, 1
s_cmp_eq_u32 s85, 0
s_cbranch_scc1 L_cntd_9
s_sleep 1
s_branch L_cnt_8
L_cntd_9:
v_and_b32 v9, 15, v1
v_lshrrev_b32 v10, 4, v1
s_lshl_b32 s42, s38, 12
s_add_u32 s42, s42, 135168
v_lshlrev_b32 v11, 8, v10
v_add_u32 v11, s42, v11
s_lshl_b32 s43, s38, 1
s_add_u32 s43, s43, 0
v_xor_b32 v12, s43, v9
v_lshlrev_b32 v12, 4, v12
v_add_u32 v12, v11, v12
ds_read_b128 v[220:223], v12 offset:0
s_lshl_b32 s43, s38, 1
s_add_u32 s43, s43, 0
v_xor_b32 v12, s43, v9
v_lshlrev_b32 v12, 4, v12
v_add_u32 v12, v11, v12
ds_read_b128 v[224:227], v12 offset:1024
s_lshl_b32 s43, s38, 1
s_add_u32 s43, s43, 1
v_xor_b32 v12, s43, v9
v_lshlrev_b32 v12, 4, v12
v_add_u32 v12, v11, v12
ds_read_b128 v[228:231], v12 offset:2048
s_lshl_b32 s43, s38, 1
s_add_u32 s43, s43, 1
v_xor_b32 v12, s43, v9
v_lshlrev_b32 v12, 4, v12
v_add_u32 v12, v11, v12
ds_read_b128 v[232:235], v12 offset:3072
v_lshlrev_b32 v10, 12, v10
v_lshlrev_b32 v9, 4, v9
v_add_u32 v10, v10, v9
s_lshl_b32 s42, s34, 18
s_lshl_b32 s43, s38, 16
s_add_u32 s42, s42, s43
s_lshl_b32 s43, s33, 8
s_sub_u32 s42, s42, s43
s_add_u32 s42, s42, 20975360
s_waitcnt lgkmcnt(3)
buffer_store_dwordx4 v[220:223], v10, s[28:31], s42 offen sc1
s_add_u32 s42, s42, 16384
s_waitcnt lgkmcnt(2)
buffer_store_dwordx4 v[224:227], v10, s[28:31], s42 offen sc1
s_add_u32 s42, s42, 16384
s_waitcnt lgkmcnt(1)
buffer_store_dwordx4 v[228:231], v10, s[28:31], s42 offen sc1
s_add_u32 s42, s42, 16384
s_waitcnt lgkmcnt(0)
buffer_store_dwordx4 v[232:235], v10, s[28:31], s42 offen sc1
v_and_b32 v108, 15, v1
v_lshrrev_b32 v109, 4, v1
v_lshrrev_b32 v110, 2, v108
v_sub_u32 v110, 0, v110
v_and_b32 v110, 3, v110
v_xor_b32 v110, v110, v109
v_lshlrev_b32 v110, 4, v110
v_lshlrev_b32 v111, 6, v108
v_add_u32 v10, v110, v111
s_lshl_b32 s42, s83, 12
v_add_u32 v10, s42, v10
v_lshrrev_b32 v110, 2, v108
v_lshlrev_b32 v111, 3, v109
v_add_u32 v110, v110, v111
v_mul_u32_u24 v110, 448, v110
v_and_b32 v111, 3, v108
v_lshlrev_b32 v111, 3, v111
v_add_u32 v110, v110, v111
v_add_u32 v110, 16384, v110
v_and_b32 v111, 1, v109
v_lshlrev_b32 v111, 5, v111
s_lshl_b32 s42, s84, 8
v_add_u32 v11, v110, v111
v_add_u32 v11, s42, v11
v_sub_u32 v12, v110, v111
v_add_u32 v12, s42, v12
v_add_u32 v13, v110, v111
v_add_u32 v13, 192, v13
v_sub_u32 v110, v110, v111
v_add_u32 v110, 224, v110
s_cmp_eq_u32 s84, 1
s_cselect_b64 vcc, -1, 0
v_cndmask_b32 v13, v13, v110, vcc
v_mov_b32 v112, 0
v_mov_b32 v113, 0
v_mov_b32 v114, 0
v_mov_b32 v115, 0
v_mov_b32 v116, 0
v_mov_b32 v117, 0
v_mov_b32 v118, 0
v_mov_b32 v119, 0
v_mov_b32 v120, 0
v_mov_b32 v121, 0
v_mov_b32 v122, 0
v_mov_b32 v123, 0
v_mov_b32 v124, 0
v_mov_b32 v125, 0
v_mov_b32 v126, 0
v_mov_b32 v127, 0
v_mov_b32 v128, 0
v_mov_b32 v129, 0
v_mov_b32 v130, 0
v_mov_b32 v131, 0
v_mov_b32 v132, 0
v_mov_b32 v133, 0
v_mov_b32 v134, 0
v_mov_b32 v135, 0
v_mov_b32 v136, 0
v_mov_b32 v137, 0
v_mov_b32 v138, 0
v_mov_b32 v139, 0
v_mov_b32 v140, 0
v_mov_b32 v141, 0
v_mov_b32 v142, 0
v_mov_b32 v143, 0
v_mov_b32 v144, 0
v_mov_b32 v145, 0
v_mov_b32 v146, 0
v_mov_b32 v147, 0
v_mov_b32 v148, 0
v_mov_b32 v149, 0
v_mov_b32 v150, 0
v_mov_b32 v151, 0
v_mov_b32 v152, 0
v_mov_b32 v153, 0
v_mov_b32 v154, 0
v_mov_b32 v155, 0
v_mov_b32 v156, 0
v_mov_b32 v157, 0
v_mov_b32 v158, 0
v_mov_b32 v159, 0
v_mov_b32 v160, 0
v_mov_b32 v161, 0
v_mov_b32 v162, 0
v_mov_b32 v163, 0
v_mov_b32 v164, 0
v_mov_b32 v165, 0
v_mov_b32 v166, 0
v_mov_b32 v167, 0
v_mov_b32 v168, 0
v_mov_b32 v169, 0
v_mov_b32 v170, 0
v_mov_b32 v171, 0
v_mov_b32 v172, 0
v_mov_b32 v173, 0
v_mov_b32 v174, 0
v_mov_b32 v175, 0
v_mov_b32 v176, 0
v_mov_b32 v177, 0
v_mov_b32 v178, 0
v_mov_b32 v179, 0
v_mov_b32 v180, 0
v_mov_b32 v181, 0
v_mov_b32 v182, 0
v_mov_b32 v183, 0
v_mov_b32 v184, 0
v_mov_b32 v185, 0
v_mov_b32 v186, 0
v_mov_b32 v187, 0
v_mov_b32 v188, 0
v_mov_b32 v189, 0
v_mov_b32 v190, 0
v_mov_b32 v191, 0
v_mov_b32 v192, 0
v_mov_b32 v193, 0
v_mov_b32 v194, 0
v_mov_b32 v195, 0
v_mov_b32 v196, 0
v_mov_b32 v197, 0
v_mov_b32 v198, 0
v_mov_b32 v199, 0
v_mov_b32 v200, 0
v_mov_b32 v201, 0
v_mov_b32 v202, 0
v_mov_b32 v203, 0
v_mov_b32 v204, 0
v_mov_b32 v205, 0
v_mov_b32 v206, 0
v_mov_b32 v207, 0
v_mov_b32 v208, 0
v_mov_b32 v209, 0
v_mov_b32 v210, 0
v_mov_b32 v211, 0
v_mov_b32 v212, 0
v_mov_b32 v213, 0
v_mov_b32 v214, 0
v_mov_b32 v215, 0
v_mov_b32 v216, 0
v_mov_b32 v217, 0
v_mov_b32 v218, 0
v_mov_b32 v219, 0
v_mov_b32 v220, 0
v_mov_b32 v221, 0
v_mov_b32 v222, 0
v_mov_b32 v223, 0
v_mov_b32 v104, v10
v_mov_b32 v105, v11
v_mov_b32 v106, v12
v_mov_b32 v107, v13
s_mov_b32 s76, 0
v_and_b32 v108, 15, v1
v_lshrrev_b32 v109, 4, v1
v_add_u32 v110, 1, v108
v_and_b32 v111, 3, v110
v_mul_u32_u24 v111, 4160, v111
v_and_b32 v110, 28, v110
v_lshlrev_b32 v2, 3, v109
v_add_u32 v110, v110, v2
v_lshlrev_b32 v110, 1, v110
v_add_u32 v2, v110, v111
s_mul_i32 s42, s38, 16640
s_add_u32 s42, s42, 65536
v_add_u32 v2, s42, v2
v_lshlrev_b32 v110, 5, v108
v_lshlrev_b32 v111, 4, v109
v_sub_u32 v3, v111, v110
s_mul_i32 s42, s38, 5120
s_add_u32 s43, s42, 135648
v_add_u32 v3, s43, v3
v_lshlrev_b32 v111, 3, v109
v_add_u32 v110, v110, v111
s_add_u32 s43, s42, 135672
v_sub_u32 v4, s43, v110
s_lshl_b32 s44, s2, 2
s_add_u32 s44, s44, s38
s_lshr_b32 s45, s44, 1
s_lshl_b32 s45, s45, 2
s_load_dword s46, s[14:15], s45
s_waitcnt lgkmcnt(0)
s_and_b32 s44, s44, 1
s_lshl_b32 s44, s44, 4
s_lshr_b32 s46, s46, s44
s_lshl_b32 s86, s46, 16
v_mov_b32 v110, 155648
s_mov_b32 s85, 160000
L_gn_10:
ds_read_b64 v[108:109], v110
s_waitcnt lgkmcnt(0)
v_readfirstlane_b32 s40, v108
v_readfirstlane_b32 s41, v109
s_nop 2
s_cmp_lg_u32 s40, 0
s_cbranch_scc1 L_gnd_11
s_sub_u32 s85, s85, 1
s_cmp_eq_u32 s85, 0
s_cbranch_scc1 L_gnd_11
s_sleep 1
s_branch L_gn_10
L_gnd_11:
s_barrier
ds_read_b128 v[44:47], v104 offset:0
ds_read_b64_tr_b16 v[16:17], v105 offset:0
ds_read_b64_tr_b16 v[18:19], v105 offset:1792
ds_read_b128 v[48:51], v104 offset:1024
ds_read_b128 v[52:55], v104 offset:2048
ds_read_b128 v[56:59], v104 offset:3072
ds_read_b64_tr_b16 v[20:21], v106 offset:32
ds_read_b64_tr_b16 v[22:23], v106 offset:1824
ds_read_b64_tr_b16 v[24:25], v105 offset:64
ds_read_b64_tr_b16 v[26:27], v105 offset:1856
ds_read_b64_tr_b16 v[28:29], v106 offset:96
ds_read_b64_tr_b16 v[30:31], v106 offset:1888
ds_read_b64_tr_b16 v[32:33], v105 offset:128
ds_read_b64_tr_b16 v[34:35], v105 offset:1920
ds_read_b64_tr_b16 v[36:37], v106 offset:160
ds_read_b64_tr_b16 v[38:39], v106 offset:1952
ds_read_b64_tr_b16 v[40:41], v107 offset:0
ds_read_b64_tr_b16 v[42:43], v107 offset:1792
s_mov_b32 s80, 15
.p2align 6
L_g1:
s_waitcnt lgkmcnt(15)
v_mfma_f32_16x16x32_bf16 v[112:115], v[16:19], v[44:47], v[112:115]
ds_read_b128 v[88:91], v104 offset:8192
s_waitcnt lgkmcnt(15)
v_mfma_f32_16x16x32_bf16 v[116:119], v[16:19], v[48:51], v[116:119]
ds_read_b64_tr_b16 v[60:61], v105 offset:14336
s_waitcnt lgkmcnt(15)
v_mfma_f32_16x16x32_bf16 v[120:123], v[16:19], v[52:55], v[120:123]
ds_read_b64_tr_b16 v[62:63], v105 offset:16128
s_waitcnt lgkmcnt(15)
v_mfma_f32_16x16x32_bf16 v[124:127], v[16:19], v[56:59], v[124:127]
ds_read_b128 v[92:95], v104 offset:9216
s_waitcnt lgkmcnt(14)
v_mfma_f32_16x16x32_bf16 v[140:143], v[20:23], v[56:59], v[140:143]
ds_read_b128 v[96:99], v104 offset:10240
v_mfma_f32_16x16x32_bf16 v[136:139], v[20:23], v[52:55], v[136:139]
ds_read_b128 v[100:103], v104 offset:11264
v_mfma_f32_16x16x32_bf16 v[132:135], v[20:23], v[48:51], v[132:135]
ds_read_b64_tr_b16 v[64:65], v106 offset:14368
v_mfma_f32_16x16x32_bf16 v[128:131], v[20:23], v[44:47], v[128:131]
ds_read_b64_tr_b16 v[66:67], v106 offset:16160
s_waitcnt lgkmcnt(15)
v_mfma_f32_16x16x32_bf16 v[144:147], v[24:27], v[44:47], v[144:147]
ds_read_b64_tr_b16 v[68:69], v105 offset:14400
v_mfma_f32_16x16x32_bf16 v[148:151], v[24:27], v[48:51], v[148:151]
ds_read_b64_tr_b16 v[70:71], v105 offset:16192
v_mfma_f32_16x16x32_bf16 v[152:155], v[24:27], v[52:55], v[152:155]
ds_read_b64_tr_b16 v[72:73], v106 offset:14432
v_mfma_f32_16x16x32_bf16 v[156:159], v[24:27], v[56:59], v[156:159]
ds_read_b64_tr_b16 v[74:75], v106 offset:16224
s_waitcnt lgkmcnt(15)
v_mfma_f32_16x16x32_bf16 v[172:175], v[28:31], v[56:59], v[172:175]
ds_read_b64_tr_b16 v[76:77], v105 offset:14464
v_mfma_f32_16x16x32_bf16 v[168:171], v[28:31], v[52:55], v[168:171]
ds_read_b64_tr_b16 v[78:79], v105 offset:16256
v_mfma_f32_16x16x32_bf16 v[164:167], v[28:31], v[48:51], v[164:167]
ds_read_b64_tr_b16 v[80:81], v106 offset:14496
v_mfma_f32_16x16x32_bf16 v[160:163], v[28:31], v[44:47], v[160:163]
ds_read_b64_tr_b16 v[82:83], v106 offset:16288
s_waitcnt lgkmcnt(15)
v_mfma_f32_16x16x32_bf16 v[176:179], v[32:35], v[44:47], v[176:179]
ds_read_b64_tr_b16 v[84:85], v107 offset:14336
v_mfma_f32_16x16x32_bf16 v[180:183], v[32:35], v[48:51], v[180:183]
ds_read_b64_tr_b16 v[86:87], v107 offset:16128
v_mfma_f32_16x16x32_bf16 v[184:187], v[32:35], v[52:55], v[184:187]
v_mfma_f32_16x16x32_bf16 v[188:191], v[32:35], v[56:59], v[188:191]
s_waitcnt lgkmcnt(15)
v_mfma_f32_16x16x32_bf16 v[204:207], v[36:39], v[56:59], v[204:207]
v_mfma_f32_16x16x32_bf16 v[200:203], v[36:39], v[52:55], v[200:203]
v_mfma_f32_16x16x32_bf16 v[196:199], v[36:39], v[48:51], v[196:199]
v_mfma_f32_16x16x32_bf16 v[192:195], v[36:39], v[44:47], v[192:195]
s_waitcnt lgkmcnt(15)
v_mfma_f32_16x16x32_bf16 v[208:211], v[40:43], v[44:47], v[208:211]
v_mfma_f32_16x16x32_bf16 v[212:215], v[40:43], v[48:51], v[212:215]
v_mfma_f32_16x16x32_bf16 v[216:219], v[40:43], v[52:55], v[216:219]
v_mfma_f32_16x16x32_bf16 v[220:223], v[40:43], v[56:59], v[220:223]
s_waitcnt vmcnt(0) lgkmcnt(0)
s_barrier
s_add_u32 s76, s76, 45056
s_cmp_eq_u32 s76, 135168
s_cselect_b32 s76, 0, s76
v_add_u32 v104, s76, v10
v_add_u32 v105, s76, v11
v_add_u32 v106, s76, v12
v_add_u32 v107, s76, v13
v_mfma_f32_16x16x32_bf16 v[112:115], v[60:63], v[88:91], v[112:115]
ds_read_b128 v[44:47], v104 offset:0
v_mfma_f32_16x16x32_bf16 v[116:119], v[60:63], v[92:95], v[116:119]
ds_read_b64_tr_b16 v[16:17], v105 offset:0
v_mfma_f32_16x16x32_bf16 v[120:123], v[60:63], v[96:99], v[120:123]
ds_read_b64_tr_b16 v[18:19], v105 offset:1792
v_mfma_f32_16x16x32_bf16 v[124:127], v[60:63], v[100:103], v[124:127]
ds_read_b128 v[48:51], v104 offset:1024
v_mfma_f32_16x16x32_bf16 v[140:143], v[64:67], v[100:103], v[140:143]
ds_read_b128 v[52:55], v104 offset:2048
v_mfma_f32_16x16x32_bf16 v[136:139], v[64:67], v[96:99], v[136:139]
ds_read_b128 v[56:59], v104 offset:3072
v_mfma_f32_16x16x32_bf16 v[132:135], v[64:67], v[92:95], v[132:135]
ds_read_b64_tr_b16 v[20:21], v106 offset:32
v_mfma_f32_16x16x32_bf16 v[128:131], v[64:67], v[88:91], v[128:131]
ds_read_b64_tr_b16 v[22:23], v106 offset:1824
v_mfma_f32_16x16x32_bf16 v[144:147], v[68:71], v[88:91], v[144:147]
ds_read_b64_tr_b16 v[24:25], v105 offset:64
v_mfma_f32_16x16x32_bf16 v[148:151], v[68:71], v[92:95], v[148:151]
ds_read_b64_tr_b16 v[26:27], v105 offset:1856
v_mfma_f32_16x16x32_bf16 v[152:155], v[68:71], v[96:99], v[152:155]
ds_read_b64_tr_b16 v[28:29], v106 offset:96
v_mfma_f32_16x16x32_bf16 v[156:159], v[68:71], v[100:103], v[156:159]
ds_read_b64_tr_b16 v[30:31], v106 offset:1888
v_mfma_f32_16x16x32_bf16 v[172:175], v[72:75], v[100:103], v[172:175]
ds_read_b64_tr_b16 v[32:33], v105 offset:128
v_mfma_f32_16x16x32_bf16 v[168:171], v[72:75], v[96:99], v[168:171]
ds_read_b64_tr_b16 v[34:35], v105 offset:1920
v_mfma_f32_16x16x32_bf16 v[164:167], v[72:75], v[92:95], v[164:167]
ds_read_b64_tr_b16 v[36:37], v106 offset:160
v_mfma_f32_16x16x32_bf16 v[160:163], v[72:75], v[88:91], v[160:163]
ds_read_b64_tr_b16 v[38:39], v106 offset:1952
v_mfma_f32_16x16x32_bf16 v[176:179], v[76:79], v[88:91], v[176:179]
ds_read_b64_tr_b16 v[40:41], v107 offset:0
v_mfma_f32_16x16x32_bf16 v[180:183], v[76:79], v[92:95], v[180:183]
ds_read_b64_tr_b16 v[42:43], v107 offset:1792
v_mfma_f32_16x16x32_bf16 v[184:187], v[76:79], v[96:99], v[184:187]
v_mfma_f32_16x16x32_bf16 v[188:191], v[76:79], v[100:103], v[188:191]
v_mfma_f32_16x16x32_bf16 v[204:207], v[80:83], v[100:103], v[204:207]
v_mfma_f32_16x16x32_bf16 v[200:203], v[80:83], v[96:99], v[200:203]
v_mfma_f32_16x16x32_bf16 v[196:199], v[80:83], v[92:95], v[196:199]
v_mfma_f32_16x16x32_bf16 v[192:195], v[80:83], v[88:91], v[192:195]
v_mfma_f32_16x16x32_bf16 v[208:211], v[84:87], v[88:91], v[208:211]
v_mfma_f32_16x16x32_bf16 v[212:215], v[84:87], v[92:95], v[212:215]
v_mfma_f32_16x16x32_bf16 v[216:219], v[84:87], v[96:99], v[216:219]
v_mfma_f32_16x16x32_bf16 v[220:223], v[84:87], v[100:103], v[220:223]
s_sub_u32 s80, s80, 1
s_cmp_lg_u32 s80, 0
s_cbranch_scc1 L_g1
s_waitcnt lgkmcnt(15)
v_mfma_f32_16x16x32_bf16 v[112:115], v[16:19], v[44:47], v[112:115]
ds_read_b128 v[88:91], v104 offset:8192
s_waitcnt lgkmcnt(15)
v_mfma_f32_16x16x32_bf16 v[116:119], v[16:19], v[48:51], v[116:119]
ds_read_b64_tr_b16 v[60:61], v105 offset:14336
s_waitcnt lgkmcnt(15)
v_mfma_f32_16x16x32_bf16 v[120:123], v[16:19], v[52:55], v[120:123]
ds_read_b64_tr_b16 v[62:63], v105 offset:16128
s_waitcnt lgkmcnt(15)
v_mfma_f32_16x16x32_bf16 v[124:127], v[16:19], v[56:59], v[124:127]
ds_read_b128 v[92:95], v104 offset:9216
s_waitcnt lgkmcnt(14)
v_mfma_f32_16x16x32_bf16 v[140:143], v[20:23], v[56:59], v[140:143]
ds_read_b128 v[96:99], v104 offset:10240
v_mfma_f32_16x16x32_bf16 v[136:139], v[20:23], v[52:55], v[136:139]
ds_read_b128 v[100:103], v104 offset:11264
v_mfma_f32_16x16x32_bf16 v[132:135], v[20:23], v[48:51], v[132:135]
ds_read_b64_tr_b16 v[64:65], v106 offset:14368
v_mfma_f32_16x16x32_bf16 v[128:131], v[20:23], v[44:47], v[128:131]
ds_read_b64_tr_b16 v[66:67], v106 offset:16160
s_waitcnt lgkmcnt(15)
v_mfma_f32_16x16x32_bf16 v[144:147], v[24:27], v[44:47], v[144:147]
ds_read_b64_tr_b16 v[68:69], v105 offset:14400
v_mfma_f32_16x16x32_bf16 v[148:151], v[24:27], v[48:51], v[148:151]
ds_read_b64_tr_b16 v[70:71], v105 offset:16192
v_mfma_f32_16x16x32_bf16 v[152:155], v[24:27], v[52:55], v[152:155]
ds_read_b64_tr_b16 v[72:73], v106 offset:14432
v_mfma_f32_16x16x32_bf16 v[156:159], v[24:27], v[56:59], v[156:159]
ds_read_b64_tr_b16 v[74:75], v106 offset:16224
s_waitcnt lgkmcnt(15)
v_mfma_f32_16x16x32_bf16 v[172:175], v[28:31], v[56:59], v[172:175]
ds_read_b64_tr_b16 v[76:77], v105 offset:14464
v_mfma_f32_16x16x32_bf16 v[168:171], v[28:31], v[52:55], v[168:171]
ds_read_b64_tr_b16 v[78:79], v105 offset:16256
v_mfma_f32_16x16x32_bf16 v[164:167], v[28:31], v[48:51], v[164:167]
ds_read_b64_tr_b16 v[80:81], v106 offset:14496
v_mfma_f32_16x16x32_bf16 v[160:163], v[28:31], v[44:47], v[160:163]
ds_read_b64_tr_b16 v[82:83], v106 offset:16288
s_waitcnt lgkmcnt(15)
v_mfma_f32_16x16x32_bf16 v[176:179], v[32:35], v[44:47], v[176:179]
ds_read_b64_tr_b16 v[84:85], v107 offset:14336
v_mfma_f32_16x16x32_bf16 v[180:183], v[32:35], v[48:51], v[180:183]
ds_read_b64_tr_b16 v[86:87], v107 offset:16128
v_mfma_f32_16x16x32_bf16 v[184:187], v[32:35], v[52:55], v[184:187]
v_mfma_f32_16x16x32_bf16 v[188:191], v[32:35], v[56:59], v[188:191]
s_waitcnt lgkmcnt(15)
v_mfma_f32_16x16x32_bf16 v[204:207], v[36:39], v[56:59], v[204:207]
v_mfma_f32_16x16x32_bf16 v[200:203], v[36:39], v[52:55], v[200:203]
v_mfma_f32_16x16x32_bf16 v[196:199], v[36:39], v[48:51], v[196:199]
v_mfma_f32_16x16x32_bf16 v[192:195], v[36:39], v[44:47], v[192:195]
s_waitcnt lgkmcnt(15)
v_mfma_f32_16x16x32_bf16 v[208:211], v[40:43], v[44:47], v[208:211]
v_mfma_f32_16x16x32_bf16 v[212:215], v[40:43], v[48:51], v[212:215]
v_mfma_f32_16x16x32_bf16 v[216:219], v[40:43], v[52:55], v[216:219]
v_mfma_f32_16x16x32_bf16 v[220:223], v[40:43], v[56:59], v[220:223]
s_waitcnt vmcnt(0) lgkmcnt(0)
s_barrier
v_mfma_f32_16x16x32_bf16 v[112:115], v[60:63], v[88:91], v[112:115]
v_mfma_f32_16x16x32_bf16 v[116:119], v[60:63], v[92:95], v[116:119]
v_mfma_f32_16x16x32_bf16 v[120:123], v[60:63], v[96:99], v[120:123]
v_mfma_f32_16x16x32_bf16 v[124:127], v[60:63], v[100:103], v[124:127]
v_mfma_f32_16x16x32_bf16 v[140:143], v[64:67], v[100:103], v[140:143]
v_mfma_f32_16x16x32_bf16 v[136:139], v[64:67], v[96:99], v[136:139]
v_mfma_f32_16x16x32_bf16 v[132:135], v[64:67], v[92:95], v[132:135]
v_mfma_f32_16x16x32_bf16 v[128:131], v[64:67], v[88:91], v[128:131]
v_mfma_f32_16x16x32_bf16 v[144:147], v[68:71], v[88:91], v[144:147]
v_mfma_f32_16x16x32_bf16 v[148:151], v[68:71], v[92:95], v[148:151]
v_mfma_f32_16x16x32_bf16 v[152:155], v[68:71], v[96:99], v[152:155]
v_mfma_f32_16x16x32_bf16 v[156:159], v[68:71], v[100:103], v[156:159]
v_mfma_f32_16x16x32_bf16 v[172:175], v[72:75], v[100:103], v[172:175]
v_mfma_f32_16x16x32_bf16 v[168:171], v[72:75], v[96:99], v[168:171]
v_mfma_f32_16x16x32_bf16 v[164:167], v[72:75], v[92:95], v[164:167]
v_mfma_f32_16x16x32_bf16 v[160:163], v[72:75], v[88:91], v[160:163]
v_mfma_f32_16x16x32_bf16 v[176:179], v[76:79], v[88:91], v[176:179]
v_mfma_f32_16x16x32_bf16 v[180:183], v[76:79], v[92:95], v[180:183]
v_mfma_f32_16x16x32_bf16 v[184:187], v[76:79], v[96:99], v[184:187]
v_mfma_f32_16x16x32_bf16 v[188:191], v[76:79], v[100:103], v[188:191]
v_mfma_f32_16x16x32_bf16 v[204:207], v[80:83], v[100:103], v[204:207]
v_mfma_f32_16x16x32_bf16 v[200:203], v[80:83], v[96:99], v[200:203]
v_mfma_f32_16x16x32_bf16 v[196:199], v[80:83], v[92:95], v[196:199]
v_mfma_f32_16x16x32_bf16 v[192:195], v[80:83], v[88:91], v[192:195]
v_mfma_f32_16x16x32_bf16 v[208:211], v[84:87], v[88:91], v[208:211]
v_mfma_f32_16x16x32_bf16 v[212:215], v[84:87], v[92:95], v[212:215]
v_mfma_f32_16x16x32_bf16 v[216:219], v[84:87], v[96:99], v[216:219]
v_mfma_f32_16x16x32_bf16 v[220:223], v[84:87], v[100:103], v[220:223]
s_lshl_b32 s42, s84, 15
v_add_u32 v104, s42, v10
v_cvt_pk_bf16_f32 v16, v112, v113
v_cvt_pk_bf16_f32 v17, v114, v115
v_cvt_pk_bf16_f32 v18, v128, v129
v_cvt_pk_bf16_f32 v19, v130, v131
v_pk_max_i16 v16, v16, 0
v_pk_max_i16 v17, v17, 0
v_pk_max_i16 v18, v18, 0
v_pk_max_i16 v19, v19, 0
ds_write_b128 v104, v[16:19] offset:0
v_cvt_pk_bf16_f32 v20, v116, v117
v_cvt_pk_bf16_f32 v21, v118, v119
v_cvt_pk_bf16_f32 v22, v132, v133
v_cvt_pk_bf16_f32 v23, v134, v135
v_pk_max_i16 v20, v20, 0
v_pk_max_i16 v21, v21, 0
v_pk_max_i16 v22, v22, 0
v_pk_max_i16 v23, v23, 0
ds_write_b128 v104, v[20:23] offset:1024
v_cvt_pk_bf16_f32 v24, v120, v121
v_cvt_pk_bf16_f32 v25, v122, v123
v_cvt_pk_bf16_f32 v26, v136, v137
v_cvt_pk_bf16_f32 v27, v138, v139
v_pk_max_i16 v24, v24, 0
v_pk_max_i16 v25, v25, 0
v_pk_max_i16 v26, v26, 0
v_pk_max_i16 v27, v27, 0
ds_write_b128 v104, v[24:27] offset:2048
v_cvt_pk_bf16_f32 v28, v124, v125
v_cvt_pk_bf16_f32 v29, v126, v127
v_cvt_pk_bf16_f32 v30, v140, v141
v_cvt_pk_bf16_f32 v31, v142, v143
v_pk_max_i16 v28, v28, 0
v_pk_max_i16 v29, v29, 0
v_pk_max_i16 v30, v30, 0
v_pk_max_i16 v31, v31, 0
ds_write_b128 v104, v[28:31] offset:3072
v_cvt_pk_bf16_f32 v32, v144, v145
v_cvt_pk_bf16_f32 v33, v146, v147
v_cvt_pk_bf16_f32 v34, v160, v161
v_cvt_pk_bf16_f32 v35, v162, v163
v_pk_max_i16 v32, v32, 0
v_pk_max_i16 v33, v33, 0
v_pk_max_i16 v34, v34, 0
v_pk_max_i16 v35, v35, 0
ds_write_b128 v104, v[32:35] offset:8192
v_cvt_pk_bf16_f32 v36, v148, v149
v_cvt_pk_bf16_f32 v37, v150, v151
v_cvt_pk_bf16_f32 v38, v164, v165
v_cvt_pk_bf16_f32 v39, v166, v167
v_pk_max_i16 v36, v36, 0
v_pk_max_i16 v37, v37, 0
v_pk_max_i16 v38, v38, 0
v_pk_max_i16 v39, v39, 0
ds_write_b128 v104, v[36:39] offset:9216
v_cvt_pk_bf16_f32 v40, v152, v153
v_cvt_pk_bf16_f32 v41, v154, v155
v_cvt_pk_bf16_f32 v42, v168, v169
v_cvt_pk_bf16_f32 v43, v170, v171
v_pk_max_i16 v40, v40, 0
v_pk_max_i16 v41, v41, 0
v_pk_max_i16 v42, v42, 0
v_pk_max_i16 v43, v43, 0
ds_write_b128 v104, v[40:43] offset:10240
v_cvt_pk_bf16_f32 v44, v156, v157
v_cvt_pk_bf16_f32 v45, v158, v159
v_cvt_pk_bf16_f32 v46, v172, v173
v_cvt_pk_bf16_f32 v47, v174, v175
v_pk_max_i16 v44, v44, 0
v_pk_max_i16 v45, v45, 0
v_pk_max_i16 v46, v46, 0
v_pk_max_i16 v47, v47, 0
ds_write_b128 v104, v[44:47] offset:11264
v_cvt_pk_bf16_f32 v16, v176, v177
v_cvt_pk_bf16_f32 v17, v178, v179
v_cvt_pk_bf16_f32 v18, v192, v193
v_cvt_pk_bf16_f32 v19, v194, v195
v_pk_max_i16 v16, v16, 0
v_pk_max_i16 v17, v17, 0
v_pk_max_i16 v18, v18, 0
v_pk_max_i16 v19, v19, 0
ds_write_b128 v104, v[16:19] offset:16384
v_cvt_pk_bf16_f32 v20, v180, v181
v_cvt_pk_bf16_f32 v21, v182, v183
v_cvt_pk_bf16_f32 v22, v196, v197
v_cvt_pk_bf16_f32 v23, v198, v199
v_pk_max_i16 v20, v20, 0
v_pk_max_i16 v21, v21, 0
v_pk_max_i16 v22, v22, 0
v_pk_max_i16 v23, v23, 0
ds_write_b128 v104, v[20:23] offset:17408
v_cvt_pk_bf16_f32 v24, v184, v185
v_cvt_pk_bf16_f32 v25, v186, v187
v_cvt_pk_bf16_f32 v26, v200, v201
v_cvt_pk_bf16_f32 v27, v202, v203
v_pk_max_i16 v24, v24, 0
v_pk_max_i16 v25, v25, 0
v_pk_max_i16 v26, v26, 0
v_pk_max_i16 v27, v27, 0
ds_write_b128 v104, v[24:27] offset:18432
v_cvt_pk_bf16_f32 v28, v188, v189
v_cvt_pk_bf16_f32 v29, v190, v191
v_cvt_pk_bf16_f32 v30, v204, v205
v_cvt_pk_bf16_f32 v31, v206, v207
v_pk_max_i16 v28, v28, 0
v_pk_max_i16 v29, v29, 0
v_pk_max_i16 v30, v30, 0
v_pk_max_i16 v31, v31, 0
ds_write_b128 v104, v[28:31] offset:19456
s_lshl_b32 s42, s84, 3
s_add_u32 s42, s42, 24576
v_add_u32 v104, s42, v10
v_cvt_pk_bf16_f32 v60, v208, v209
v_cvt_pk_bf16_f32 v61, v210, v211
v_pk_max_i16 v60, v60, 0
v_pk_max_i16 v61, v61, 0
ds_write_b64 v104, v[60:61] offset:0
v_cvt_pk_bf16_f32 v62, v212, v213
v_cvt_pk_bf16_f32 v63, v214, v215
v_pk_max_i16 v62, v62, 0
v_pk_max_i16 v63, v63, 0
ds_write_b64 v104, v[62:63] offset:1024
v_cvt_pk_bf16_f32 v64, v216, v217
v_cvt_pk_bf16_f32 v65, v218, v219
v_pk_max_i16 v64, v64, 0
v_pk_max_i16 v65, v65, 0
ds_write_b64 v104, v[64:65] offset:2048
v_cvt_pk_bf16_f32 v66, v220, v221
v_cvt_pk_bf16_f32 v67, v222, v223
v_pk_max_i16 v66, v66, 0
v_pk_max_i16 v67, v67, 0
ds_write_b64 v104, v[66:67] offset:3072
v_mov_b32 v112, 0
v_mov_b32 v113, 0
v_mov_b32 v114, 0
v_mov_b32 v115, 0
v_mov_b32 v116, 0
v_mov_b32 v117, 0
v_mov_b32 v118, 0
v_mov_b32 v119, 0
v_mov_b32 v120, 0
v_mov_b32 v121, 0
v_mov_b32 v122, 0
v_mov_b32 v123, 0
v_mov_b32 v124, 0
v_mov_b32 v125, 0
v_mov_b32 v126, 0
v_mov_b32 v127, 0
v_mov_b32 v128, 0
v_mov_b32 v129, 0
v_mov_b32 v130, 0
v_mov_b32 v131, 0
v_mov_b32 v132, 0
v_mov_b32 v133, 0
v_mov_b32 v134, 0
v_mov_b32 v135, 0
v_mov_b32 v136, 0
v_mov_b32 v137, 0
v_mov_b32 v138, 0
v_mov_b32 v139, 0
v_mov_b32 v140, 0
v_mov_b32 v141, 0
v_mov_b32 v142, 0
v_mov_b32 v143, 0
s_waitcnt lgkmcnt(0)
s_barrier
ds_read_b64 v[16:17], v2 offset:0
ds_read_b64 v[18:19], v2 offset:8
ds_read_b128 v[48:51], v3 offset:3584
ds_read_b128 v[52:55], v3 offset:3072
ds_read_b128 v[56:59], v3 offset:2560
ds_read_b128 v[60:63], v3 offset:2048
ds_read_b128 v[64:67], v3 offset:1536
ds_read_b128 v[68:71], v3 offset:1024
ds_read_b128 v[72:75], v3 offset:512
ds_read_b128 v[76:79], v3 offset:0
ds_read_b64 v[20:21], v2 offset:512
ds_read_b64 v[22:23], v2 offset:520
ds_read_b64 v[24:25], v2 offset:1024
ds_read_b64 v[26:27], v2 offset:1032
ds_read_b64 v[28:29], v2 offset:1536
ds_read_b64 v[30:31], v2 offset:1544
ds_read_b64 v[32:33], v2 offset:2048
ds_read_b64 v[34:35], v2 offset:2056
ds_read_b64 v[36:37], v2 offset:2560
ds_read_b64 v[38:39], v2 offset:2568
ds_read_b64 v[40:41], v2 offset:3072
ds_read_b64 v[42:43], v2 offset:3080
ds_read_b64 v[44:45], v2 offset:3584
ds_read_b64 v[46:47], v2 offset:3592
s_mov_b32 s80, 4
.p2align 6
L_conv:
s_waitcnt lgkmcnt(15)
v_mfma_f32_16x16x32_bf16 v[112:115], v[16:19], v[48:51], v[112:115]
ds_read_b64 v[144:145], v2 offset:64
s_waitcnt lgkmcnt(15)
v_mfma_f32_16x16x32_bf16 v[116:119], v[16:19], v[52:55], v[116:119]
ds_read_b64 v[146:147], v2 offset:72
s_waitcnt lgkmcnt(15)
v_mfma_f32_16x16x32_bf16 v[120:123], v[16:19], v[56:59], v[120:123]
ds_read_b128 v[176:179], v3 offset:3648
s_waitcnt lgkmcnt(15)
v_mfma_f32_16x16x32_bf16 v[124:127], v[16:19], v[60:63], v[124:127]
ds_read_b128 v[180:183], v3 offset:3136
s_waitcnt lgkmcnt(15)
v_mfma_f32_16x16x32_bf16 v[128:131], v[16:19], v[64:67], v[128:131]
ds_read_b128 v[184:187], v3 offset:2624
s_waitcnt lgkmcnt(15)
v_mfma_f32_16x16x32_bf16 v[132:135], v[16:19], v[68:71], v[132:135]
ds_read_b128 v[188:191], v3 offset:2112
s_waitcnt lgkmcnt(15)
v_mfma_f32_16x16x32_bf16 v[136:139], v[16:19], v[72:75], v[136:139]
ds_read_b128 v[192:195], v3 offset:1600
s_waitcnt lgkmcnt(15)
v_mfma_f32_16x16x32_bf16 v[140:143], v[16:19], v[76:79], v[140:143]
ds_read_b128 v[196:199], v3 offset:1088
s_waitcnt lgkmcnt(15)
v_mfma_f32_16x16x32_bf16 v[116:119], v[20:23], v[48:51], v[116:119]
ds_read_b128 v[200:203], v3 offset:576
v_mfma_f32_16x16x32_bf16 v[120:123], v[20:23], v[52:55], v[120:123]
ds_read_b128 v[204:207], v3 offset:64
v_mfma_f32_16x16x32_bf16 v[124:127], v[20:23], v[56:59], v[124:127]
ds_read_b64 v[148:149], v2 offset:576
v_mfma_f32_16x16x32_bf16 v[128:131], v[20:23], v[60:63], v[128:131]
ds_read_b64 v[150:151], v2 offset:584
v_mfma_f32_16x16x32_bf16 v[132:135], v[20:23], v[64:67], v[132:135]
ds_read_b64 v[152:153], v2 offset:1088
v_mfma_f32_16x16x32_bf16 v[136:139], v[20:23], v[68:71], v[136:139]
ds_read_b64 v[154:155], v2 offset:1096
v_mfma_f32_16x16x32_bf16 v[140:143], v[20:23], v[72:75], v[140:143]
ds_read_b64 v[156:157], v2 offset:1600
s_waitcnt lgkmcnt(15)
v_mfma_f32_16x16x32_bf16 v[120:123], v[24:27], v[48:51], v[120:123]
ds_read_b64 v[158:159], v2 offset:1608
v_mfma_f32_16x16x32_bf16 v[124:127], v[24:27], v[52:55], v[124:127]
ds_read_b64 v[160:161], v2 offset:2112
v_mfma_f32_16x16x32_bf16 v[128:131], v[24:27], v[56:59], v[128:131]
ds_read_b64 v[162:163], v2 offset:2120
v_mfma_f32_16x16x32_bf16 v[132:135], v[24:27], v[60:63], v[132:135]
ds_read_b64 v[164:165], v2 offset:2624
v_mfma_f32_16x16x32_bf16 v[136:139], v[24:27], v[64:67], v[136:139]
ds_read_b64 v[166:167], v2 offset:2632
v_mfma_f32_16x16x32_bf16 v[140:143], v[24:27], v[68:71], v[140:143]
ds_read_b64 v[168:169], v2 offset:3136
s_waitcnt lgkmcnt(15)
v_mfma_f32_16x16x32_bf16 v[124:127], v[28:31], v[48:51], v[124:127]
ds_read_b64 v[170:171], v2 offset:3144
v_mfma_f32_16x16x32_bf16 v[128:131], v[28:31], v[52:55], v[128:131]
ds_read_b64 v[172:173], v2 offset:3648
v_mfma_f32_16x16x32_bf16 v[132:135], v[28:31], v[56:59], v[132:135]
ds_read_b64 v[174:175], v2 offset:3656
v_mfma_f32_16x16x32_bf16 v[136:139], v[28:31], v[60:63], v[136:139]
v_mfma_f32_16x16x32_bf16 v[140:143], v[28:31], v[64:67], v[140:143]
s_waitcnt lgkmcnt(15)
v_mfma_f32_16x16x32_bf16 v[128:131], v[32:35], v[48:51], v[128:131]
v_mfma_f32_16x16x32_bf16 v[132:135], v[32:35], v[52:55], v[132:135]
v_mfma_f32_16x16x32_bf16 v[136:139], v[32:35], v[56:59], v[136:139]
v_mfma_f32_16x16x32_bf16 v[140:143], v[32:35], v[60:63], v[140:143]
s_waitcnt lgkmcnt(15)
v_mfma_f32_16x16x32_bf16 v[132:135], v[36:39], v[48:51], v[132:135]
v_mfma_f32_16x16x32_bf16 v[136:139], v[36:39], v[52:55], v[136:139]
v_mfma_f32_16x16x32_bf16 v[140:143], v[36:39], v[56:59], v[140:143]
s_waitcnt lgkmcnt(15)
v_mfma_f32_16x16x32_bf16 v[136:139], v[40:43], v[48:51], v[136:139]
v_mfma_f32_16x16x32_bf16 v[140:143], v[40:43], v[52:55], v[140:143]
s_waitcnt lgkmcnt(15)
v_mfma_f32_16x16x32_bf16 v[140:143], v[44:47], v[48:51], v[140:143]
s_waitcnt lgkmcnt(15)
v_mfma_f32_16x16x32_bf16 v[112:115], v[144:147], v[176:179], v[112:115]
ds_read_b64 v[16:17], v2 offset:128
s_waitcnt lgkmcnt(15)
v_mfma_f32_16x16x32_bf16 v[116:119], v[144:147], v[180:183], v[116:119]
ds_read_b64 v[18:19], v2 offset:136
s_waitcnt lgkmcnt(15)
v_mfma_f32_16x16x32_bf16 v[120:123], v[144:147], v[184:187], v[120:123]
ds_read_b128 v[48:51], v3 offset:3712
s_waitcnt lgkmcnt(15)
v_mfma_f32_16x16x32_bf16 v[124:127], v[144:147], v[188:191], v[124:127]
ds_read_b128 v[52:55], v3 offset:3200
s_waitcnt lgkmcnt(15)
v_mfma_f32_16x16x32_bf16 v[128:131], v[144:147], v[192:195], v[128:131]
ds_read_b128 v[56:59], v3 offset:2688
s_waitcnt lgkmcnt(15)
v_mfma_f32_16x16x32_bf16 v[132:135], v[144:147], v[196:199], v[132:135]
ds_read_b128 v[60:63], v3 offset:2176
s_waitcnt lgkmcnt(15)
v_mfma_f32_16x16x32_bf16 v[136:139], v[144:147], v[200:203], v[136:139]
ds_read_b128 v[64:67], v3 offset:1664
s_waitcnt lgkmcnt(15)
v_mfma_f32_16x16x32_bf16 v[140:143], v[144:147], v[204:207], v[140:143]
ds_read_b128 v[68:71], v3 offset:1152
s_waitcnt lgkmcnt(15)
v_mfma_f32_16x16x32_bf16 v[116:119], v[148:151], v[176:179], v[116:119]
ds_read_b128 v[72:75], v3 offset:640
v_mfma_f32_16x16x32_bf16 v[120:123], v[148:151], v[180:183], v[120:123]
ds_read_b128 v[76:79], v3 offset:128
v_mfma_f32_16x16x32_bf16 v[124:127], v[148:151], v[184:187], v[124:127]
ds_read_b64 v[20:21], v2 offset:640
v_mfma_f32_16x16x32_bf16 v[128:131], v[148:151], v[188:191], v[128:131]
ds_read_b64 v[22:23], v2 offset:648
v_mfma_f32_16x16x32_bf16 v[132:135], v[148:151], v[192:195], v[132:135]
ds_read_b64 v[24:25], v2 offset:1152
v_mfma_f32_16x16x32_bf16 v[136:139], v[148:151], v[196:199], v[136:139]
ds_read_b64 v[26:27], v2 offset:1160
v_mfma_f32_16x16x32_bf16 v[140:143], v[148:151], v[200:203], v[140:143]
ds_read_b64 v[28:29], v2 offset:1664
s_waitcnt lgkmcnt(15)
v_mfma_f32_16x16x32_bf16 v[120:123], v[152:155], v[176:179], v[120:123]
ds_read_b64 v[30:31], v2 offset:1672
v_mfma_f32_16x16x32_bf16 v[124:127], v[152:155], v[180:183], v[124:127]
ds_read_b64 v[32:33], v2 offset:2176
v_mfma_f32_16x16x32_bf16 v[128:131], v[152:155], v[184:187], v[128:131]
ds_read_b64 v[34:35], v2 offset:2184
v_mfma_f32_16x16x32_bf16 v[132:135], v[152:155], v[188:191], v[132:135]
ds_read_b64 v[36:37], v2 offset:2688
v_mfma_f32_16x16x32_bf16 v[136:139], v[152:155], v[192:195], v[136:139]
ds_read_b64 v[38:39], v2 offset:2696
v_mfma_f32_16x16x32_bf16 v[140:143], v[152:155], v[196:199], v[140:143]
ds_read_b64 v[40:41], v2 offset:3200
s_waitcnt lgkmcnt(15)
v_mfma_f32_16x16x32_bf16 v[124:127], v[156:159], v[176:179], v[124:127]
ds_read_b64 v[42:43], v2 offset:3208
v_mfma_f32_16x16x32_bf16 v[128:131], v[156:159], v[180:183], v[128:131]
ds_read_b64 v[44:45], v2 offset:3712
v_mfma_f32_16x16x32_bf16 v[132:135], v[156:159], v[184:187], v[132:135]
ds_read_b64 v[46:47], v2 offset:3720
v_mfma_f32_16x16x32_bf16 v[136:139], v[156:159], v[188:191], v[136:139]
v_mfma_f32_16x16x32_bf16 v[140:143], v[156:159], v[192:195], v[140:143]
s_waitcnt lgkmcnt(15)
v_mfma_f32_16x16x32_bf16 v[128:131], v[160:163], v[176:179], v[128:131]
v_mfma_f32_16x16x32_bf16 v[132:135], v[160:163], v[180:183], v[132:135]
v_mfma_f32_16x16x32_bf16 v[136:139], v[160:163], v[184:187], v[136:139]
v_mfma_f32_16x16x32_bf16 v[140:143], v[160:163], v[188:191], v[140:143]
s_waitcnt lgkmcnt(15)
v_mfma_f32_16x16x32_bf16 v[132:135], v[164:167], v[176:179], v[132:135]
v_add_u32 v2, 128, v2
v_add_u32 v3, 128, v3
v_mfma_f32_16x16x32_bf16 v[136:139], v[164:167], v[180:183], v[136:139]
v_mfma_f32_16x16x32_bf16 v[140:143], v[164:167], v[184:187], v[140:143]
s_waitcnt lgkmcnt(15)
v_mfma_f32_16x16x32_bf16 v[136:139], v[168:171], v[176:179], v[136:139]
v_mfma_f32_16x16x32_bf16 v[140:143], v[168:171], v[180:183], v[140:143]
s_waitcnt lgkmcnt(15)
v_mfma_f32_16x16x32_bf16 v[140:143], v[172:175], v[176:179], v[140:143]
s_sub_u32 s80, s80, 1
s_cmp_lg_u32 s80, 0
s_cbranch_scc1 L_conv
s_waitcnt lgkmcnt(0)
v_mov_b32 v110, 155684
v_mov_b32 v111, 1
s_mov_b64 exec, 1
ds_add_u32 v110, v111
s_mov_b64 exec, -1
s_waitcnt lgkmcnt(0)
v_and_b32 v108, 15, v1
v_lshrrev_b32 v109, 4, v1
ds_read_b64 v[16:17], v4 offset:3584
ds_read_b64 v[18:19], v4 offset:3072
ds_read_b64 v[20:21], v4 offset:2560
ds_read_b64 v[22:23], v4 offset:2048
ds_read_b64 v[24:25], v4 offset:1536
ds_read_b64 v[26:27], v4 offset:1024
ds_read_b64 v[28:29], v4 offset:512
ds_read_b64 v[30:31], v4 offset:0
v_and_b32 v110, 1, v109
v_lshlrev_b32 v110, 1, v110
v_lshrrev_b32 v111, 3, v108
v_add_u32 v110, v110, v111
v_lshlrev_b32 v110, 18, v110
v_lshrrev_b32 v111, 1, v109
v_lshlrev_b32 v111, 4, v111
v_and_b32 v2, 7, v108
v_lshlrev_b32 v2, 5, v2
v_add3_u32 v2, v2, v110, v111
s_lshl_b32 s42, s2, 2
s_add_u32 s42, s42, s38
s_lshr_b32 s43, s42, 5
s_lshl_b32 s43, s43, 13
s_and_b32 s42, s42, 31
s_lshl_b32 s42, s42, 8
s_add_u32 s42, s42, s43
s_add_u32 s42, s42, 25165824
s_waitcnt lgkmcnt(0)
v_and_b32 v32, 0xffff0000, v17
v_lshlrev_b32 v33, 16, v17
v_and_b32 v34, 0xffff0000, v16
v_lshlrev_b32 v35, 16, v16
v_fmac_f32 v112, s86, v32
v_fmac_f32 v113, s86, v33
v_fmac_f32 v114, s86, v34
v_fmac_f32 v115, s86, v35
v_cvt_pk_bf16_f32 v48, v112, v113
v_cvt_pk_bf16_f32 v49, v114, v115
v_and_b32 v32, 0xffff0000, v19
v_lshlrev_b32 v33, 16, v19
v_and_b32 v34, 0xffff0000, v18
v_lshlrev_b32 v35, 16, v18
v_fmac_f32 v116, s86, v32
v_fmac_f32 v117, s86, v33
v_fmac_f32 v118, s86, v34
v_fmac_f32 v119, s86, v35
v_cvt_pk_bf16_f32 v50, v116, v117
v_cvt_pk_bf16_f32 v51, v118, v119
s_nop 0
v_permlane16_swap_b32 v48, v50
v_permlane16_swap_b32 v49, v51
buffer_store_dwordx4 v[48:51], v2, s[28:31], s42 offen sc1
s_add_u32 s42, s42, 1048576
v_and_b32 v32, 0xffff0000, v21
v_lshlrev_b32 v33, 16, v21
v_and_b32 v34, 0xffff0000, v20
v_lshlrev_b32 v35, 16, v20
v_fmac_f32 v120, s86, v32
v_fmac_f32 v121, s86, v33
v_fmac_f32 v122, s86, v34
v_fmac_f32 v123, s86, v35
v_cvt_pk_bf16_f32 v52, v120, v121
v_cvt_pk_bf16_f32 v53, v122, v123
v_and_b32 v32, 0xffff0000, v23
v_lshlrev_b32 v33, 16, v23
v_and_b32 v34, 0xffff0000, v22
v_lshlrev_b32 v35, 16, v22
v_fmac_f32 v124, s86, v32
v_fmac_f32 v125, s86, v33
v_fmac_f32 v126, s86, v34
v_fmac_f32 v127, s86, v35
v_cvt_pk_bf16_f32 v54, v124, v125
v_cvt_pk_bf16_f32 v55, v126, v127
s_nop 0
v_permlane16_swap_b32 v52, v54
v_permlane16_swap_b32 v53, v55
buffer_store_dwordx4 v[52:55], v2, s[28:31], s42 offen sc1
s_add_u32 s42, s42, 1048576
v_and_b32 v32, 0xffff0000, v25
v_lshlrev_b32 v33, 16, v25
v_and_b32 v34, 0xffff0000, v24
v_lshlrev_b32 v35, 16, v24
v_fmac_f32 v128, s86, v32
v_fmac_f32 v129, s86, v33
v_fmac_f32 v130, s86, v34
v_fmac_f32 v131, s86, v35
v_cvt_pk_bf16_f32 v56, v128, v129
v_cvt_pk_bf16_f32 v57, v130, v131
v_and_b32 v32, 0xffff0000, v27
v_lshlrev_b32 v33, 16, v27
v_and_b32 v34, 0xffff0000, v26
v_lshlrev_b32 v35, 16, v26
v_fmac_f32 v132, s86, v32
v_fmac_f32 v133, s86, v33
v_fmac_f32 v134, s86, v34
v_fmac_f32 v135, s86, v35
v_cvt_pk_bf16_f32 v58, v132, v133
v_cvt_pk_bf16_f32 v59, v134, v135
s_nop 0
v_permlane16_swap_b32 v56, v58
v_permlane16_swap_b32 v57, v59
buffer_store_dwordx4 v[56:59], v2, s[28:31], s42 offen sc1
s_add_u32 s42, s42, 1048576
v_and_b32 v32, 0xffff0000, v29
v_lshlrev_b32 v33, 16, v29
v_and_b32 v34, 0xffff0000, v28
v_lshlrev_b32 v35, 16, v28
v_fmac_f32 v136, s86, v32
v_fmac_f32 v137, s86, v33
v_fmac_f32 v138, s86, v34
v_fmac_f32 v139, s86, v35
v_cvt_pk_bf16_f32 v60, v136, v137
v_cvt_pk_bf16_f32 v61, v138, v139
v_and_b32 v32, 0xffff0000, v31
v_lshlrev_b32 v33, 16, v31
v_and_b32 v34, 0xffff0000, v30
v_lshlrev_b32 v35, 16, v30
v_fmac_f32 v140, s86, v32
v_fmac_f32 v141, s86, v33
v_fmac_f32 v142, s86, v34
v_fmac_f32 v143, s86, v35
v_cvt_pk_bf16_f32 v62, v140, v141
v_cvt_pk_bf16_f32 v63, v142, v143
s_nop 0
v_permlane16_swap_b32 v60, v62
v_permlane16_swap_b32 v61, v63
buffer_store_dwordx4 v[60:63], v2, s[28:31], s42 offen sc1
v_and_b32 v224, 15, v1
v_lshrrev_b32 v225, 4, v1
v_lshrrev_b32 v226, 2, v224
v_sub_u32 v226, 0, v226
v_and_b32 v226, 3, v226
v_xor_b32 v226, v226, v225
v_lshlrev_b32 v226, 4, v226
v_lshlrev_b32 v227, 6, v224
v_add_u32 v10, v226, v227
s_lshl_b32 s42, s83, 12
v_add_u32 v10, s42, v10
v_lshrrev_b32 v226, 2, v224
v_lshlrev_b32 v227, 2, v225
v_add_u32 v226, v226, v227
v_and_b32 v228, 7, v226
v_lshlrev_b32 v228, 1, v228
v_lshlrev_b32 v226, 8, v226
v_add_u32 v226, 16384, v226
v_and_b32 v227, 1, v224
v_lshlrev_b32 v227, 3, v227
v_add_u32 v226, v226, v227
v_bfe_u32 v227, v224, 1, 1
s_xor_b32 s42, s37, 0
s_lshl_b32 s42, s42, 3
s_lshl_b32 s43, s84, 2
s_add_u32 s42, s42, s43
v_add_u32 v229, s42, v227
v_xor_b32 v229, v229, v228
v_lshlrev_b32 v229, 4, v229
v_add_u32 v11, v226, v229
s_xor_b32 s42, s37, 0
s_lshl_b32 s42, s42, 3
s_lshl_b32 s43, s84, 2
s_add_u32 s42, s42, s43
s_add_u32 s42, s42, 2
v_add_u32 v229, s42, v227
v_xor_b32 v229, v229, v228
v_lshlrev_b32 v229, 4, v229
v_add_u32 v12, v226, v229
s_xor_b32 s42, s37, 1
s_lshl_b32 s42, s42, 3
s_lshl_b32 s43, s84, 2
s_add_u32 s42, s42, s43
v_add_u32 v229, s42, v227
v_xor_b32 v229, v229, v228
v_lshlrev_b32 v229, 4, v229
v_add_u32 v13, v226, v229
s_xor_b32 s42, s37, 1
s_lshl_b32 s42, s42, 3
s_lshl_b32 s43, s84, 2
s_add_u32 s42, s42, s43
s_add_u32 s42, s42, 2
v_add_u32 v229, s42, v227
v_xor_b32 v229, v229, v228
v_lshlrev_b32 v229, 4, v229
v_add_u32 v14, v226, v229
v_mov_b32 v112, 0
v_mov_b32 v113, 0
v_mov_b32 v114, 0
v_mov_b32 v115, 0
v_mov_b32 v116, 0
v_mov_b32 v117, 0
v_mov_b32 v118, 0
v_mov_b32 v119, 0
v_mov_b32 v120, 0
v_mov_b32 v121, 0
v_mov_b32 v122, 0
v_mov_b32 v123, 0
v_mov_b32 v124, 0
v_mov_b32 v125, 0
v_mov_b32 v126, 0
v_mov_b32 v127, 0
v_mov_b32 v128, 0
v_mov_b32 v129, 0
v_mov_b32 v130, 0
v_mov_b32 v131, 0
v_mov_b32 v132, 0
v_mov_b32 v133, 0
v_mov_b32 v134, 0
v_mov_b32 v135, 0
v_mov_b32 v136, 0
v_mov_b32 v137, 0
v_mov_b32 v138, 0
v_mov_b32 v139, 0
v_mov_b32 v140, 0
v_mov_b32 v141, 0
v_mov_b32 v142, 0
v_mov_b32 v143, 0
v_mov_b32 v144, 0
v_mov_b32 v145, 0
v_mov_b32 v146, 0
v_mov_b32 v147, 0
v_mov_b32 v148, 0
v_mov_b32 v149, 0
v_mov_b32 v150, 0
v_mov_b32 v151, 0
v_mov_b32 v152, 0
v_mov_b32 v153, 0
v_mov_b32 v154, 0
v_mov_b32 v155, 0
v_mov_b32 v156, 0
v_mov_b32 v157, 0
v_mov_b32 v158, 0
v_mov_b32 v159, 0
v_mov_b32 v160, 0
v_mov_b32 v161, 0
v_mov_b32 v162, 0
v_mov_b32 v163, 0
v_mov_b32 v164, 0
v_mov_b32 v165, 0
v_mov_b32 v166, 0
v_mov_b32 v167, 0
v_mov_b32 v168, 0
v_mov_b32 v169, 0
v_mov_b32 v170, 0
v_mov_b32 v171, 0
v_mov_b32 v172, 0
v_mov_b32 v173, 0
v_mov_b32 v174, 0
v_mov_b32 v175, 0
v_mov_b32 v104, v10
v_mov_b32 v105, v11
v_mov_b32 v106, v12
v_mov_b32 v107, v13
v_mov_b32 v108, v14
s_mov_b32 s76, 0
s_barrier
ds_read_b128 v[44:47], v104 offset:0
ds_read_b64_tr_b16 v[16:17], v105 offset:0
ds_read_b64_tr_b16 v[18:19], v105 offset:4096
ds_read_b128 v[48:51], v104 offset:1024
ds_read_b128 v[52:55], v104 offset:2048
ds_read_b128 v[56:59], v104 offset:3072
ds_read_b64_tr_b16 v[20:21], v106 offset:0
ds_read_b64_tr_b16 v[22:23], v106 offset:4096
ds_read_b64_tr_b16 v[24:25], v107 offset:0
ds_read_b64_tr_b16 v[26:27], v107 offset:4096
ds_read_b64_tr_b16 v[28:29], v108 offset:0
ds_read_b64_tr_b16 v[30:31], v108 offset:4096
s_mov_b32 s80, 26
.p2align 6
L_g2:
s_waitcnt lgkmcnt(9)
v_mfma_f32_16x16x32_bf16 v[112:115], v[16:19], v[44:47], v[112:115]
ds_read_b128 v[88:91], v104 offset:8192
s_waitcnt lgkmcnt(9)
v_mfma_f32_16x16x32_bf16 v[116:119], v[16:19], v[48:51], v[116:119]
ds_read_b64_tr_b16 v[60:61], v105 offset:8192
s_waitcnt lgkmcnt(9)
v_mfma_f32_16x16x32_bf16 v[120:123], v[16:19], v[52:55], v[120:123]
ds_read_b64_tr_b16 v[62:63], v105 offset:12288
s_waitcnt lgkmcnt(9)
v_mfma_f32_16x16x32_bf16 v[124:127], v[16:19], v[56:59], v[124:127]
ds_read_b128 v[92:95], v104 offset:9216
s_waitcnt lgkmcnt(8)
v_mfma_f32_16x16x32_bf16 v[140:143], v[20:23], v[56:59], v[140:143]
ds_read_b128 v[96:99], v104 offset:10240
v_mfma_f32_16x16x32_bf16 v[136:139], v[20:23], v[52:55], v[136:139]
ds_read_b128 v[100:103], v104 offset:11264
v_mfma_f32_16x16x32_bf16 v[132:135], v[20:23], v[48:51], v[132:135]
ds_read_b64_tr_b16 v[64:65], v106 offset:8192
v_mfma_f32_16x16x32_bf16 v[128:131], v[20:23], v[44:47], v[128:131]
ds_read_b64_tr_b16 v[66:67], v106 offset:12288
s_waitcnt lgkmcnt(10)
v_mfma_f32_16x16x32_bf16 v[144:147], v[24:27], v[44:47], v[144:147]
ds_read_b64_tr_b16 v[68:69], v107 offset:8192
v_mfma_f32_16x16x32_bf16 v[148:151], v[24:27], v[48:51], v[148:151]
ds_read_b64_tr_b16 v[70:71], v107 offset:12288
v_mfma_f32_16x16x32_bf16 v[152:155], v[24:27], v[52:55], v[152:155]
ds_read_b64_tr_b16 v[72:73], v108 offset:8192
v_mfma_f32_16x16x32_bf16 v[156:159], v[24:27], v[56:59], v[156:159]
ds_read_b64_tr_b16 v[74:75], v108 offset:12288
s_waitcnt lgkmcnt(12)
v_mfma_f32_16x16x32_bf16 v[172:175], v[28:31], v[56:59], v[172:175]
v_mfma_f32_16x16x32_bf16 v[168:171], v[28:31], v[52:55], v[168:171]
v_mfma_f32_16x16x32_bf16 v[164:167], v[28:31], v[48:51], v[164:167]
v_mfma_f32_16x16x32_bf16 v[160:163], v[28:31], v[44:47], v[160:163]
s_waitcnt vmcnt(0)
s_barrier
s_add_u32 s76, s76, 32768
s_cmp_eq_u32 s76, 163840
s_cselect_b32 s76, 0, s76
v_add_u32 v104, s76, v10
v_add_u32 v105, s76, v11
v_add_u32 v106, s76, v12
v_add_u32 v107, s76, v13
v_add_u32 v108, s76, v14
s_waitcnt lgkmcnt(9)
v_mfma_f32_16x16x32_bf16 v[112:115], v[60:63], v[88:91], v[112:115]
ds_read_b128 v[44:47], v104 offset:0
s_waitcnt lgkmcnt(9)
v_mfma_f32_16x16x32_bf16 v[116:119], v[60:63], v[92:95], v[116:119]
ds_read_b64_tr_b16 v[16:17], v105 offset:0
s_waitcnt lgkmcnt(9)
v_mfma_f32_16x16x32_bf16 v[120:123], v[60:63], v[96:99], v[120:123]
ds_read_b64_tr_b16 v[18:19], v105 offset:4096
s_waitcnt lgkmcnt(9)
v_mfma_f32_16x16x32_bf16 v[124:127], v[60:63], v[100:103], v[124:127]
ds_read_b128 v[48:51], v104 offset:1024
s_waitcnt lgkmcnt(8)
v_mfma_f32_16x16x32_bf16 v[140:143], v[64:67], v[100:103], v[140:143]
ds_read_b128 v[52:55], v104 offset:2048
v_mfma_f32_16x16x32_bf16 v[136:139], v[64:67], v[96:99], v[136:139]
ds_read_b128 v[56:59], v104 offset:3072
v_mfma_f32_16x16x32_bf16 v[132:135], v[64:67], v[92:95], v[132:135]
ds_read_b64_tr_b16 v[20:21], v106 offset:0
v_mfma_f32_16x16x32_bf16 v[128:131], v[64:67], v[88:91], v[128:131]
ds_read_b64_tr_b16 v[22:23], v106 offset:4096
s_waitcnt lgkmcnt(10)
v_mfma_f32_16x16x32_bf16 v[144:147], v[68:71], v[88:91], v[144:147]
ds_read_b64_tr_b16 v[24:25], v107 offset:0
v_mfma_f32_16x16x32_bf16 v[148:151], v[68:71], v[92:95], v[148:151]
ds_read_b64_tr_b16 v[26:27], v107 offset:4096
v_mfma_f32_16x16x32_bf16 v[152:155], v[68:71], v[96:99], v[152:155]
ds_read_b64_tr_b16 v[28:29], v108 offset:0
v_mfma_f32_16x16x32_bf16 v[156:159], v[68:71], v[100:103], v[156:159]
ds_read_b64_tr_b16 v[30:31], v108 offset:4096
s_waitcnt lgkmcnt(12)
v_mfma_f32_16x16x32_bf16 v[172:175], v[72:75], v[100:103], v[172:175]
v_mfma_f32_16x16x32_bf16 v[168:171], v[72:75], v[96:99], v[168:171]
v_mfma_f32_16x16x32_bf16 v[164:167], v[72:75], v[92:95], v[164:167]
v_mfma_f32_16x16x32_bf16 v[160:163], v[72:75], v[88:91], v[160:163]
s_sub_u32 s80, s80, 1
s_cmp_lg_u32 s80, 0
s_cbranch_scc1 L_g2
s_waitcnt lgkmcnt(9)
v_mfma_f32_16x16x32_bf16 v[112:115], v[16:19], v[44:47], v[112:115]
ds_read_b128 v[88:91], v104 offset:8192
s_waitcnt lgkmcnt(9)
v_mfma_f32_16x16x32_bf16 v[116:119], v[16:19], v[48:51], v[116:119]
ds_read_b64_tr_b16 v[60:61], v105 offset:8192
s_waitcnt lgkmcnt(9)
v_mfma_f32_16x16x32_bf16 v[120:123], v[16:19], v[52:55], v[120:123]
ds_read_b64_tr_b16 v[62:63], v105 offset:12288
s_waitcnt lgkmcnt(9)
v_mfma_f32_16x16x32_bf16 v[124:127], v[16:19], v[56:59], v[124:127]
ds_read_b128 v[92:95], v104 offset:9216
s_waitcnt lgkmcnt(8)
v_mfma_f32_16x16x32_bf16 v[140:143], v[20:23], v[56:59], v[140:143]
ds_read_b128 v[96:99], v104 offset:10240
v_mfma_f32_16x16x32_bf16 v[136:139], v[20:23], v[52:55], v[136:139]
ds_read_b128 v[100:103], v104 offset:11264
v_mfma_f32_16x16x32_bf16 v[132:135], v[20:23], v[48:51], v[132:135]
ds_read_b64_tr_b16 v[64:65], v106 offset:8192
v_mfma_f32_16x16x32_bf16 v[128:131], v[20:23], v[44:47], v[128:131]
ds_read_b64_tr_b16 v[66:67], v106 offset:12288
s_waitcnt lgkmcnt(10)
v_mfma_f32_16x16x32_bf16 v[144:147], v[24:27], v[44:47], v[144:147]
ds_read_b64_tr_b16 v[68:69], v107 offset:8192
v_mfma_f32_16x16x32_bf16 v[148:151], v[24:27], v[48:51], v[148:151]
ds_read_b64_tr_b16 v[70:71], v107 offset:12288
v_mfma_f32_16x16x32_bf16 v[152:155], v[24:27], v[52:55], v[152:155]
ds_read_b64_tr_b16 v[72:73], v108 offset:8192
v_mfma_f32_16x16x32_bf16 v[156:159], v[24:27], v[56:59], v[156:159]
ds_read_b64_tr_b16 v[74:75], v108 offset:12288
s_waitcnt lgkmcnt(12)
v_mfma_f32_16x16x32_bf16 v[172:175], v[28:31], v[56:59], v[172:175]
v_mfma_f32_16x16x32_bf16 v[168:171], v[28:31], v[52:55], v[168:171]
v_mfma_f32_16x16x32_bf16 v[164:167], v[28:31], v[48:51], v[164:167]
v_mfma_f32_16x16x32_bf16 v[160:163], v[28:31], v[44:47], v[160:163]
s_add_u32 s76, s76, 32768
s_cmp_eq_u32 s76, 163840
s_cselect_b32 s76, 0, s76
v_add_u32 v104, s76, v10
v_add_u32 v105, s76, v11
v_add_u32 v106, s76, v12
v_add_u32 v107, s76, v13
v_add_u32 v108, s76, v14
s_waitcnt lgkmcnt(9)
v_mfma_f32_16x16x32_bf16 v[112:115], v[60:63], v[88:91], v[112:115]
ds_read_b128 v[44:47], v104 offset:0
s_waitcnt lgkmcnt(9)
v_mfma_f32_16x16x32_bf16 v[116:119], v[60:63], v[92:95], v[116:119]
ds_read_b64_tr_b16 v[16:17], v105 offset:0
s_waitcnt lgkmcnt(9)
v_mfma_f32_16x16x32_bf16 v[120:123], v[60:63], v[96:99], v[120:123]
ds_read_b64_tr_b16 v[18:19], v105 offset:4096
s_waitcnt lgkmcnt(9)
v_mfma_f32_16x16x32_bf16 v[124:127], v[60:63], v[100:103], v[124:127]
ds_read_b128 v[48:51], v104 offset:1024
s_waitcnt lgkmcnt(8)
v_mfma_f32_16x16x32_bf16 v[140:143], v[64:67], v[100:103], v[140:143]
ds_read_b128 v[52:55], v104 offset:2048
v_mfma_f32_16x16x32_bf16 v[136:139], v[64:67], v[96:99], v[136:139]
ds_read_b128 v[56:59], v104 offset:3072
v_mfma_f32_16x16x32_bf16 v[132:135], v[64:67], v[92:95], v[132:135]
ds_read_b64_tr_b16 v[20:21], v106 offset:0
v_mfma_f32_16x16x32_bf16 v[128:131], v[64:67], v[88:91], v[128:131]
ds_read_b64_tr_b16 v[22:23], v106 offset:4096
s_waitcnt lgkmcnt(10)
v_mfma_f32_16x16x32_bf16 v[144:147], v[68:71], v[88:91], v[144:147]
ds_read_b64_tr_b16 v[24:25], v107 offset:0
v_mfma_f32_16x16x32_bf16 v[148:151], v[68:71], v[92:95], v[148:151]
ds_read_b64_tr_b16 v[26:27], v107 offset:4096
v_mfma_f32_16x16x32_bf16 v[152:155], v[68:71], v[96:99], v[152:155]
ds_read_b64_tr_b16 v[28:29], v108 offset:0
v_mfma_f32_16x16x32_bf16 v[156:159], v[68:71], v[100:103], v[156:159]
ds_read_b64_tr_b16 v[30:31], v108 offset:4096
s_waitcnt lgkmcnt(12)
v_mfma_f32_16x16x32_bf16 v[172:175], v[72:75], v[100:103], v[172:175]
v_mfma_f32_16x16x32_bf16 v[168:171], v[72:75], v[96:99], v[168:171]
v_mfma_f32_16x16x32_bf16 v[164:167], v[72:75], v[92:95], v[164:167]
v_mfma_f32_16x16x32_bf16 v[160:163], v[72:75], v[88:91], v[160:163]
s_waitcnt lgkmcnt(9)
v_mfma_f32_16x16x32_bf16 v[112:115], v[16:19], v[44:47], v[112:115]
ds_read_b128 v[88:91], v104 offset:8192
s_waitcnt lgkmcnt(9)
v_mfma_f32_16x16x32_bf16 v[116:119], v[16:19], v[48:51], v[116:119]
ds_read_b64_tr_b16 v[60:61], v105 offset:8192
s_waitcnt lgkmcnt(9)
v_mfma_f32_16x16x32_bf16 v[120:123], v[16:19], v[52:55], v[120:123]
ds_read_b64_tr_b16 v[62:63], v105 offset:12288
s_waitcnt lgkmcnt(9)
v_mfma_f32_16x16x32_bf16 v[124:127], v[16:19], v[56:59], v[124:127]
ds_read_b128 v[92:95], v104 offset:9216
s_waitcnt lgkmcnt(8)
v_mfma_f32_16x16x32_bf16 v[140:143], v[20:23], v[56:59], v[140:143]
ds_read_b128 v[96:99], v104 offset:10240
v_mfma_f32_16x16x32_bf16 v[136:139], v[20:23], v[52:55], v[136:139]
ds_read_b128 v[100:103], v104 offset:11264
v_mfma_f32_16x16x32_bf16 v[132:135], v[20:23], v[48:51], v[132:135]
ds_read_b64_tr_b16 v[64:65], v106 offset:8192
v_mfma_f32_16x16x32_bf16 v[128:131], v[20:23], v[44:47], v[128:131]
ds_read_b64_tr_b16 v[66:67], v106 offset:12288
s_waitcnt lgkmcnt(10)
v_mfma_f32_16x16x32_bf16 v[144:147], v[24:27], v[44:47], v[144:147]
ds_read_b64_tr_b16 v[68:69], v107 offset:8192
v_mfma_f32_16x16x32_bf16 v[148:151], v[24:27], v[48:51], v[148:151]
ds_read_b64_tr_b16 v[70:71], v107 offset:12288
v_mfma_f32_16x16x32_bf16 v[152:155], v[24:27], v[52:55], v[152:155]
ds_read_b64_tr_b16 v[72:73], v108 offset:8192
v_mfma_f32_16x16x32_bf16 v[156:159], v[24:27], v[56:59], v[156:159]
ds_read_b64_tr_b16 v[74:75], v108 offset:12288
s_waitcnt lgkmcnt(12)
v_mfma_f32_16x16x32_bf16 v[172:175], v[28:31], v[56:59], v[172:175]
v_mfma_f32_16x16x32_bf16 v[168:171], v[28:31], v[52:55], v[168:171]
v_mfma_f32_16x16x32_bf16 v[164:167], v[28:31], v[48:51], v[164:167]
v_mfma_f32_16x16x32_bf16 v[160:163], v[28:31], v[44:47], v[160:163]
s_waitcnt lgkmcnt(9)
v_mfma_f32_16x16x32_bf16 v[112:115], v[60:63], v[88:91], v[112:115]
s_waitcnt lgkmcnt(8)
v_mfma_f32_16x16x32_bf16 v[116:119], v[60:63], v[92:95], v[116:119]
s_waitcnt lgkmcnt(7)
v_mfma_f32_16x16x32_bf16 v[120:123], v[60:63], v[96:99], v[120:123]
s_waitcnt lgkmcnt(6)
v_mfma_f32_16x16x32_bf16 v[124:127], v[60:63], v[100:103], v[124:127]
s_waitcnt lgkmcnt(4)
v_mfma_f32_16x16x32_bf16 v[140:143], v[64:67], v[100:103], v[140:143]
v_mfma_f32_16x16x32_bf16 v[136:139], v[64:67], v[96:99], v[136:139]
v_mfma_f32_16x16x32_bf16 v[132:135], v[64:67], v[92:95], v[132:135]
v_mfma_f32_16x16x32_bf16 v[128:131], v[64:67], v[88:91], v[128:131]
s_waitcnt lgkmcnt(2)
v_mfma_f32_16x16x32_bf16 v[144:147], v[68:71], v[88:91], v[144:147]
v_mfma_f32_16x16x32_bf16 v[148:151], v[68:71], v[92:95], v[148:151]
v_mfma_f32_16x16x32_bf16 v[152:155], v[68:71], v[96:99], v[152:155]
v_mfma_f32_16x16x32_bf16 v[156:159], v[68:71], v[100:103], v[156:159]
s_waitcnt lgkmcnt(0)
v_mfma_f32_16x16x32_bf16 v[172:175], v[72:75], v[100:103], v[172:175]
v_mfma_f32_16x16x32_bf16 v[168:171], v[72:75], v[96:99], v[168:171]
v_mfma_f32_16x16x32_bf16 v[164:167], v[72:75], v[92:95], v[164:167]
v_mfma_f32_16x16x32_bf16 v[160:163], v[72:75], v[88:91], v[160:163]
v_lshlrev_b32 v60, 4, v1
s_mul_i32 s42, s2, 45056
s_mul_i32 s43, s38, 11264
s_add_u32 s42, s42, s43
s_add_u32 s42, s42, 29360128
v_cvt_pk_bf16_f32 v16, v144, v145
v_cvt_pk_bf16_f32 v17, v146, v147
v_cvt_pk_bf16_f32 v18, v148, v149
v_cvt_pk_bf16_f32 v19, v150, v151
buffer_store_dwordx4 v[16:19], v60, s[28:31], s42 offen sc1
v_cvt_pk_bf16_f32 v20, v152, v153
v_cvt_pk_bf16_f32 v21, v154, v155
v_cvt_pk_bf16_f32 v22, v156, v157
v_cvt_pk_bf16_f32 v23, v158, v159
buffer_store_dwordx4 v[20:23], v60, s[28:31], s42 offen offset:1024 sc1
v_cvt_pk_bf16_f32 v24, v160, v161
v_cvt_pk_bf16_f32 v25, v162, v163
v_cvt_pk_bf16_f32 v26, v164, v165
v_cvt_pk_bf16_f32 v27, v166, v167
buffer_store_dwordx4 v[24:27], v60, s[28:31], s42 offen offset:2048 sc1
v_cvt_pk_bf16_f32 v28, v168, v169
v_cvt_pk_bf16_f32 v29, v170, v171
v_cvt_pk_bf16_f32 v30, v172, v173
v_cvt_pk_bf16_f32 v31, v174, v175
buffer_store_dwordx4 v[28:31], v60, s[28:31], s42 offen offset:3072 sc1
s_waitcnt vmcnt(0)
s_barrier
v_lshrrev_b32 v226, 2, v224
v_sub_u32 v226, 0, v226
v_and_b32 v226, 3, v226
v_lshrrev_b32 v227, 1, v225
v_and_b32 v229, 1, v225
v_lshlrev_b32 v229, 3, v229
v_lshlrev_b32 v228, 6, v224
v_add_u32 v228, v228, v229
s_lshl_b32 s42, s84, 13
s_lshl_b32 s43, s83, 12
s_add_u32 s42, s42, s43
s_add_u32 s42, s42, 131072
v_add_u32 v228, s42, v228
v_xor_b32 v222, v227, v226
v_lshlrev_b32 v222, 4, v222
v_add_u32 v222, v222, v228
v_add_u32 v217, 2, v227
v_xor_b32 v223, v217, v226
v_lshlrev_b32 v223, 4, v223
v_add_u32 v223, v223, v228
v_bfe_u32 v226, v224, 1, 3
s_lshl_b32 s42, s84, 2
v_add_u32 v227, s42, v227
v_lshlrev_b32 v228, 7, v224
v_add_u32 v228, v228, v229
s_lshl_b32 s42, s83, 13
s_add_u32 s42, s42, 114688
v_add_u32 v228, s42, v228
v_xor_b32 v216, v227, v226
v_lshlrev_b32 v216, 4, v216
v_add_u32 v216, v216, v228
v_add_u32 v227, 2, v227
v_xor_b32 v217, v227, v226
v_lshlrev_b32 v217, 4, v217
v_add_u32 v217, v217, v228
v_lshrrev_b32 v226, 2, v224
v_lshlrev_b32 v227, 2, v225
v_add_u32 v226, v226, v227
v_and_b32 v227, 7, v226
v_lshlrev_b32 v227, 1, v227
v_lshlrev_b32 v226, 8, v226
v_and_b32 v228, 1, v224
v_lshlrev_b32 v228, 3, v228
v_add_u32 v226, v226, v228
s_lshl_b32 s42, s84, 13
s_add_u32 s42, s42, 98304
v_add_u32 v226, s42, v226
v_bfe_u32 v228, v224, 1, 1
s_lshl_b32 s42, s83, 3
v_add_u32 v228, s42, v228
v_add_u32 v229, 0, v228
v_xor_b32 v229, v229, v227
v_lshlrev_b32 v229, 4, v229
v_add_u32 v218, v229, v226
v_add_u32 v229, 2, v228
v_xor_b32 v229, v229, v227
v_lshlrev_b32 v229, 4, v229
v_add_u32 v219, v229, v226
v_add_u32 v229, 4, v228
v_xor_b32 v229, v229, v227
v_lshlrev_b32 v229, 4, v229
v_add_u32 v220, v229, v226
v_add_u32 v229, 6, v228
v_xor_b32 v229, v229, v227
v_lshlrev_b32 v229, 4, v229
v_add_u32 v221, v229, v226
ds_read_b64 v[64:65], v216 offset:0
ds_read_b64 v[66:67], v222 offset:0
ds_read_b64_tr_b16 v[68:69], v218 offset:0
ds_read_b64 v[70:71], v216 offset:2048
ds_read_b64 v[72:73], v222 offset:1024
ds_read_b64_tr_b16 v[74:75], v219 offset:0
ds_read_b64 v[76:77], v216 offset:4096
ds_read_b64 v[78:79], v222 offset:2048
ds_read_b64_tr_b16 v[80:81], v220 offset:0
ds_read_b64 v[82:83], v216 offset:6144
ds_read_b64 v[84:85], v222 offset:3072
ds_read_b64_tr_b16 v[86:87], v221 offset:0
ds_read_b64 v[88:89], v217 offset:0
ds_read_b64 v[90:91], v223 offset:0
ds_read_b64_tr_b16 v[92:93], v218 offset:4096
s_waitcnt lgkmcnt(12)
ds_read_b64 v[94:95], v217 offset:2048
ds_read_b64 v[96:97], v223 offset:1024
ds_read_b64_tr_b16 v[98:99], v219 offset:4096
ds_read_b64 v[100:101], v217 offset:4096
ds_read_b64 v[102:103], v223 offset:2048
ds_read_b64_tr_b16 v[104:105], v220 offset:4096
ds_read_b64 v[106:107], v217 offset:6144
ds_read_b64 v[108:109], v223 offset:3072
ds_read_b64_tr_b16 v[110:111], v221 offset:4096
s_waitcnt lgkmcnt(15)
v_lshlrev_b32 v226, 16, v64
v_and_b32 v227, 0xffff0000, v64
v_lshlrev_b32 v228, 16, v66
v_and_b32 v229, 0xffff0000, v66
v_lshlrev_b32 v230, 16, v68
v_and_b32 v231, 0xffff0000, v68
v_fma_f32 v184, v228, v230, v226
v_fma_f32 v185, v229, v231, v227
v_lshlrev_b32 v232, 16, v65
v_and_b32 v233, 0xffff0000, v65
v_lshlrev_b32 v234, 16, v67
v_and_b32 v235, 0xffff0000, v67
v_lshlrev_b32 v236, 16, v69
v_and_b32 v237, 0xffff0000, v69
v_fma_f32 v186, v234, v236, v232
v_fma_f32 v187, v235, v237, v233
s_waitcnt lgkmcnt(15)
v_lshlrev_b32 v226, 16, v70
v_and_b32 v227, 0xffff0000, v70
v_lshlrev_b32 v228, 16, v72
v_and_b32 v229, 0xffff0000, v72
v_lshlrev_b32 v230, 16, v74
v_and_b32 v231, 0xffff0000, v74
v_fma_f32 v188, v228, v230, v226
v_fma_f32 v189, v229, v231, v227
v_lshlrev_b32 v232, 16, v71
v_and_b32 v233, 0xffff0000, v71
v_lshlrev_b32 v234, 16, v73
v_and_b32 v235, 0xffff0000, v73
v_lshlrev_b32 v236, 16, v75
v_and_b32 v237, 0xffff0000, v75
v_fma_f32 v190, v234, v236, v232
v_fma_f32 v191, v235, v237, v233
s_waitcnt lgkmcnt(15)
v_lshlrev_b32 v226, 16, v76
v_and_b32 v227, 0xffff0000, v76
v_lshlrev_b32 v228, 16, v78
v_and_b32 v229, 0xffff0000, v78
v_lshlrev_b32 v230, 16, v80
v_and_b32 v231, 0xffff0000, v80
v_fma_f32 v192, v228, v230, v226
v_fma_f32 v193, v229, v231, v227
v_lshlrev_b32 v232, 16, v77
v_and_b32 v233, 0xffff0000, v77
v_lshlrev_b32 v234, 16, v79
v_and_b32 v235, 0xffff0000, v79
v_lshlrev_b32 v236, 16, v81
v_and_b32 v237, 0xffff0000, v81
v_fma_f32 v194, v234, v236, v232
v_fma_f32 v195, v235, v237, v233
s_waitcnt lgkmcnt(12)
v_lshlrev_b32 v226, 16, v82
v_and_b32 v227, 0xffff0000, v82
v_lshlrev_b32 v228, 16, v84
v_and_b32 v229, 0xffff0000, v84
v_lshlrev_b32 v230, 16, v86
v_and_b32 v231, 0xffff0000, v86
v_fma_f32 v196, v228, v230, v226
v_fma_f32 v197, v229, v231, v227
v_lshlrev_b32 v232, 16, v83
v_and_b32 v233, 0xffff0000, v83
v_lshlrev_b32 v234, 16, v85
v_and_b32 v235, 0xffff0000, v85
v_lshlrev_b32 v236, 16, v87
v_and_b32 v237, 0xffff0000, v87
v_fma_f32 v198, v234, v236, v232
v_fma_f32 v199, v235, v237, v233
s_waitcnt lgkmcnt(9)
v_lshlrev_b32 v226, 16, v88
v_and_b32 v227, 0xffff0000, v88
v_lshlrev_b32 v228, 16, v90
v_and_b32 v229, 0xffff0000, v90
v_lshlrev_b32 v230, 16, v92
v_and_b32 v231, 0xffff0000, v92
v_fma_f32 v200, v228, v230, v226
v_fma_f32 v201, v229, v231, v227
v_lshlrev_b32 v232, 16, v89
v_and_b32 v233, 0xffff0000, v89
v_lshlrev_b32 v234, 16, v91
v_and_b32 v235, 0xffff0000, v91
v_lshlrev_b32 v236, 16, v93
v_and_b32 v237, 0xffff0000, v93
v_fma_f32 v202, v234, v236, v232
v_fma_f32 v203, v235, v237, v233
s_waitcnt lgkmcnt(6)
v_lshlrev_b32 v226, 16, v94
v_and_b32 v227, 0xffff0000, v94
v_lshlrev_b32 v228, 16, v96
v_and_b32 v229, 0xffff0000, v96
v_lshlrev_b32 v230, 16, v98
v_and_b32 v231, 0xffff0000, v98
v_fma_f32 v204, v228, v230, v226
v_fma_f32 v205, v229, v231, v227
v_lshlrev_b32 v232, 16, v95
v_and_b32 v233, 0xffff0000, v95
v_lshlrev_b32 v234, 16, v97
v_and_b32 v235, 0xffff0000, v97
v_lshlrev_b32 v236, 16, v99
v_and_b32 v237, 0xffff0000, v99
v_fma_f32 v206, v234, v236, v232
v_fma_f32 v207, v235, v237, v233
s_waitcnt lgkmcnt(3)
v_lshlrev_b32 v226, 16, v100
v_and_b32 v227, 0xffff0000, v100
v_lshlrev_b32 v228, 16, v102
v_and_b32 v229, 0xffff0000, v102
v_lshlrev_b32 v230, 16, v104
v_and_b32 v231, 0xffff0000, v104
v_fma_f32 v208, v228, v230, v226
v_fma_f32 v209, v229, v231, v227
v_lshlrev_b32 v232, 16, v101
v_and_b32 v233, 0xffff0000, v101
v_lshlrev_b32 v234, 16, v103
v_and_b32 v235, 0xffff0000, v103
v_lshlrev_b32 v236, 16, v105
v_and_b32 v237, 0xffff0000, v105
v_fma_f32 v210, v234, v236, v232
v_fma_f32 v211, v235, v237, v233
s_waitcnt lgkmcnt(0)
v_lshlrev_b32 v226, 16, v106
v_and_b32 v227, 0xffff0000, v106
v_lshlrev_b32 v228, 16, v108
v_and_b32 v229, 0xffff0000, v108
v_lshlrev_b32 v230, 16, v110
v_and_b32 v231, 0xffff0000, v110
v_fma_f32 v212, v228, v230, v226
v_fma_f32 v213, v229, v231, v227
v_lshlrev_b32 v232, 16, v107
v_and_b32 v233, 0xffff0000, v107
v_lshlrev_b32 v234, 16, v109
v_and_b32 v235, 0xffff0000, v109
v_lshlrev_b32 v236, 16, v111
v_and_b32 v237, 0xffff0000, v111
v_fma_f32 v214, v234, v236, v232
v_fma_f32 v215, v235, v237, v233
s_barrier
s_xor_b32 s42, s2, 1
s_mul_i32 s42, s42, 45056
s_mul_i32 s43, s38, 11264
s_add_u32 s42, s42, s43
s_add_u32 s42, s42, 29360128
s_add_u32 s44, s42, 4096
s_add_u32 s45, s42, 8192
s_mov_b32 s85, 20000
buffer_load_dwordx4 v[64:67], v60, s[28:31], s42 offen
buffer_load_dwordx4 v[68:71], v60, s[28:31], s42 offen offset:1024
buffer_load_dwordx4 v[72:75], v60, s[28:31], s42 offen offset:2048
buffer_load_dwordx4 v[76:79], v60, s[28:31], s42 offen offset:3072
s_mov_b32 s60, s20
s_mov_b32 s61, s21
s_mov_b32 s62, 4194304
s_mov_b32 s63, 0x20000
v_and_b32 v226, 1, v225
v_lshlrev_b32 v226, 5, v226
v_lshrrev_b32 v227, 1, v225
v_lshlrev_b32 v227, 4, v227
v_lshlrev_b32 v61, 11, v224
v_add3_u32 v61, v61, v226, v227
s_lshl_b32 s42, s35, 18
s_lshl_b32 s43, s83, 17
s_add_u32 s42, s42, s43
s_lshl_b32 s43, s95, 7
s_add_u32 s42, s42, s43
s_lshl_b32 s43, s84, 6
s_add_u32 s42, s42, s43
s_waitcnt vmcnt(0)
v_lshlrev_b32 v62, 16, v64
v_add_f32 v112, v112, v62
v_add_f32 v112, v112, v184
v_and_b32 v62, 0xffff0000, v64
v_add_f32 v113, v113, v62
v_add_f32 v113, v113, v185
v_lshlrev_b32 v62, 16, v65
v_add_f32 v114, v114, v62
v_add_f32 v114, v114, v186
v_and_b32 v62, 0xffff0000, v65
v_add_f32 v115, v115, v62
v_add_f32 v115, v115, v187
v_cvt_pk_bf16_f32 v176, v112, v113
v_cvt_pk_bf16_f32 v177, v114, v115
v_lshlrev_b32 v62, 16, v72
v_add_f32 v128, v128, v62
v_add_f32 v128, v128, v200
v_and_b32 v62, 0xffff0000, v72
v_add_f32 v129, v129, v62
v_add_f32 v129, v129, v201
v_lshlrev_b32 v62, 16, v73
v_add_f32 v130, v130, v62
v_add_f32 v130, v130, v202
v_and_b32 v62, 0xffff0000, v73
v_add_f32 v131, v131, v62
v_add_f32 v131, v131, v203
v_cvt_pk_bf16_f32 v178, v128, v129
v_cvt_pk_bf16_f32 v179, v130, v131
s_nop 0
v_permlane16_swap_b32 v176, v178
v_permlane16_swap_b32 v177, v179
buffer_store_dwordx4 v[176:179], v61, s[60:63], s42 offen
s_add_u32 s42, s42, 32768
v_lshlrev_b32 v62, 16, v66
v_add_f32 v116, v116, v62
v_add_f32 v116, v116, v188
v_and_b32 v62, 0xffff0000, v66
v_add_f32 v117, v117, v62
v_add_f32 v117, v117, v189
v_lshlrev_b32 v62, 16, v67
v_add_f32 v118, v118, v62
v_add_f32 v118, v118, v190
v_and_b32 v62, 0xffff0000, v67
v_add_f32 v119, v119, v62
v_add_f32 v119, v119, v191
v_cvt_pk_bf16_f32 v180, v116, v117
v_cvt_pk_bf16_f32 v181, v118, v119
v_lshlrev_b32 v62, 16, v74
v_add_f32 v132, v132, v62
v_add_f32 v132, v132, v204
v_and_b32 v62, 0xffff0000, v74
v_add_f32 v133, v133, v62
v_add_f32 v133, v133, v205
v_lshlrev_b32 v62, 16, v75
v_add_f32 v134, v134, v62
v_add_f32 v134, v134, v206
v_and_b32 v62, 0xffff0000, v75
v_add_f32 v135, v135, v62
v_add_f32 v135, v135, v207
v_cvt_pk_bf16_f32 v182, v132, v133
v_cvt_pk_bf16_f32 v183, v134, v135
s_nop 0
v_permlane16_swap_b32 v180, v182
v_permlane16_swap_b32 v181, v183
buffer_store_dwordx4 v[180:183], v61, s[60:63], s42 offen
s_add_u32 s42, s42, 32768
v_lshlrev_b32 v62, 16, v68
v_add_f32 v120, v120, v62
v_add_f32 v120, v120, v192
v_and_b32 v62, 0xffff0000, v68
v_add_f32 v121, v121, v62
v_add_f32 v121, v121, v193
v_lshlrev_b32 v62, 16, v69
v_add_f32 v122, v122, v62
v_add_f32 v122, v122, v194
v_and_b32 v62, 0xffff0000, v69
v_add_f32 v123, v123, v62
v_add_f32 v123, v123, v195
v_cvt_pk_bf16_f32 v176, v120, v121
v_cvt_pk_bf16_f32 v177, v122, v123
v_lshlrev_b32 v62, 16, v76
v_add_f32 v136, v136, v62
v_add_f32 v136, v136, v208
v_and_b32 v62, 0xffff0000, v76
v_add_f32 v137, v137, v62
v_add_f32 v137, v137, v209
v_lshlrev_b32 v62, 16, v77
v_add_f32 v138, v138, v62
v_add_f32 v138, v138, v210
v_and_b32 v62, 0xffff0000, v77
v_add_f32 v139, v139, v62
v_add_f32 v139, v139, v211
v_cvt_pk_bf16_f32 v178, v136, v137
v_cvt_pk_bf16_f32 v179, v138, v139
s_nop 0
v_permlane16_swap_b32 v176, v178
v_permlane16_swap_b32 v177, v179
buffer_store_dwordx4 v[176:179], v61, s[60:63], s42 offen
s_add_u32 s42, s42, 32768
v_lshlrev_b32 v62, 16, v70
v_add_f32 v124, v124, v62
v_add_f32 v124, v124, v196
v_and_b32 v62, 0xffff0000, v70
v_add_f32 v125, v125, v62
v_add_f32 v125, v125, v197
v_lshlrev_b32 v62, 16, v71
v_add_f32 v126, v126, v62
v_add_f32 v126, v126, v198
v_and_b32 v62, 0xffff0000, v71
v_add_f32 v127, v127, v62
v_add_f32 v127, v127, v199
v_cvt_pk_bf16_f32 v180, v124, v125
v_cvt_pk_bf16_f32 v181, v126, v127
v_lshlrev_b32 v62, 16, v78
v_add_f32 v140, v140, v62
v_add_f32 v140, v140, v212
v_and_b32 v62, 0xffff0000, v78
v_add_f32 v141, v141, v62
v_add_f32 v141, v141, v213
v_lshlrev_b32 v62, 16, v79
v_add_f32 v142, v142, v62
v_add_f32 v142, v142, v214
v_and_b32 v62, 0xffff0000, v79
v_add_f32 v143, v143, v62
v_add_f32 v143, v143, v215
v_cvt_pk_bf16_f32 v182, v140, v141
v_cvt_pk_bf16_f32 v183, v142, v143
s_nop 0
v_permlane16_swap_b32 v180, v182
v_permlane16_swap_b32 v181, v183
buffer_store_dwordx4 v[180:183], v61, s[60:63], s42 offen
s_branch L_exit
L_roleH:
s_cmp_lg_u32 s38, 2
s_cbranch_scc1 L_only_12
v_mov_b32 v32, 0
v_mov_b32 v33, 0
v_mov_b32 v34, 0
v_mov_b32 v35, 0
v_mov_b32 v36, 155648
ds_write_b128 v36, v[32:35]
ds_write_b128 v36, v[32:35] offset:16
ds_write_b128 v36, v[32:35] offset:32
s_waitcnt lgkmcnt(0)
L_only_12:
v_min_u32 v120, 55, v1
v_lshlrev_b32 v120, 7, v120
s_lshr_b32 s42, s2, 4
s_sub_u32 s92, s42, 6
s_cmp_le_u32 s42, 5
s_cselect_b32 s92, 99, s92
s_cbranch_scc0 L_t0_13
s_mov_b32 s64, s16
s_mov_b32 s65, s17
s_mov_b32 s66, 7340032
s_mov_b32 s67, 0x20000
s_lshl_b32 s46, s2, 2
s_add_u32 s46, s46, s38
s_mul_i32 s46, s46, 7168
buffer_load_dword v124, v120, s[64:67], s46 offen
L_t0_13:
s_mul_i32 s42, s2, 5958
s_lshr_b32 s42, s42, 16
s_mul_i32 s42, s42, 11
s_sub_u32 s93, s2, s42
s_add_u32 s93, s93, 1
s_add_u32 s43, s2, 4
s_mul_i32 s42, s43, 7282
s_lshr_b32 s42, s42, 16
s_mul_i32 s42, s42, 9
s_sub_u32 s94, s43, s42
s_add_u32 s94, s94, 2
s_cmp_eq_u32 s92, 99
s_cselect_b32 s93, s93, s92
s_mov_b32 s94, s93
s_mul_i32 s42, s34, 448
s_add_u32 s60, s16, s42
s_addc_u32 s61, s17, 0
s_sub_u32 s62, 7340032, s42
s_mov_b32 s63, 0x20000
s_mul_i32 s42, s38, 448
s_add_u32 s42, s42, 0
v_add_u32 v32, s42, v1
v_mul_u32_u24 v33, 2341, v32
v_lshrrev_b32 v33, 16, v33
v_mul_u32_u24 v34, 28, v33
v_sub_u32 v34, v32, v34
v_bfe_u32 v35, v33, 3, 1
v_lshlrev_b32 v35, 1, v35
v_xor_b32 v34, v34, v35
v_mul_u32_u24 v33, 7168, v33
v_lshlrev_b32 v34, 4, v34
v_add_u32 v16, v33, v34
s_mul_i32 s42, s38, 448
s_add_u32 s42, s42, 64
v_add_u32 v32, s42, v1
v_mul_u32_u24 v33, 2341, v32
v_lshrrev_b32 v33, 16, v33
v_mul_u32_u24 v34, 28, v33
v_sub_u32 v34, v32, v34
v_bfe_u32 v35, v33, 3, 1
v_lshlrev_b32 v35, 1, v35
v_xor_b32 v34, v34, v35
v_mul_u32_u24 v33, 7168, v33
v_lshlrev_b32 v34, 4, v34
v_add_u32 v17, v33, v34
v_subrev_u32 v17, 1024, v17
s_mul_i32 s42, s38, 448
s_add_u32 s42, s42, 128
v_add_u32 v32, s42, v1
v_mul_u32_u24 v33, 2341, v32
v_lshrrev_b32 v33, 16, v33
v_mul_u32_u24 v34, 28, v33
v_sub_u32 v34, v32, v34
v_bfe_u32 v35, v33, 3, 1
v_lshlrev_b32 v35, 1, v35
v_xor_b32 v34, v34, v35
v_mul_u32_u24 v33, 7168, v33
v_lshlrev_b32 v34, 4, v34
v_add_u32 v18, v33, v34
v_subrev_u32 v18, 2048, v18
s_mul_i32 s42, s38, 448
s_add_u32 s42, s42, 192
v_add_u32 v32, s42, v1
v_mul_u32_u24 v33, 2341, v32
v_lshrrev_b32 v33, 16, v33
v_mul_u32_u24 v34, 28, v33
v_sub_u32 v34, v32, v34
v_bfe_u32 v35, v33, 3, 1
v_lshlrev_b32 v35, 1, v35
v_xor_b32 v34, v34, v35
v_mul_u32_u24 v33, 7168, v33
v_lshlrev_b32 v34, 4, v34
v_add_u32 v19, v33, v34
v_subrev_u32 v19, 3072, v19
s_mul_i32 s42, s38, 448
s_add_u32 s42, s42, 256
v_add_u32 v32, s42, v1
v_mul_u32_u24 v33, 2341, v32
v_lshrrev_b32 v33, 16, v33
v_mul_u32_u24 v34, 28, v33
v_sub_u32 v34, v32, v34
v_bfe_u32 v35, v33, 3, 1
v_lshlrev_b32 v35, 1, v35
v_xor_b32 v34, v34, v35
v_mul_u32_u24 v33, 7168, v33
v_lshlrev_b32 v34, 4, v34
v_add_u32 v20, v33, v34
s_mul_i32 s42, s38, 448
s_add_u32 s42, s42, 320
v_add_u32 v32, s42, v1
v_mul_u32_u24 v33, 2341, v32
v_lshrrev_b32 v33, 16, v33
v_mul_u32_u24 v34, 28, v33
v_sub_u32 v34, v32, v34
v_bfe_u32 v35, v33, 3, 1
v_lshlrev_b32 v35, 1, v35
v_xor_b32 v34, v34, v35
v_mul_u32_u24 v33, 7168, v33
v_lshlrev_b32 v34, 4, v34
v_add_u32 v21, v33, v34
v_subrev_u32 v21, 1024, v21
s_mul_i32 s42, s38, 448
s_add_u32 s42, s42, 384
v_add_u32 v32, s42, v1
v_mul_u32_u24 v33, 2341, v32
v_lshrrev_b32 v33, 16, v33
v_mul_u32_u24 v34, 28, v33
v_sub_u32 v34, v32, v34
v_bfe_u32 v35, v33, 3, 1
v_lshlrev_b32 v35, 1, v35
v_xor_b32 v34, v34, v35
v_mul_u32_u24 v33, 7168, v33
v_lshlrev_b32 v34, 4, v34
v_add_u32 v22, v33, v34
v_subrev_u32 v22, 2048, v22
v_lshlrev_b32 v30, 4, v1
s_mul_i32 s82, s38, 7168
s_add_u32 s82, s82, 16384
s_lshl_b32 s81, s38, 12
s_mov_b32 s79, 0
s_barrier
v_mov_b32 v34, 155672
s_mov_b32 s85, 20000
L_cnt_14:
ds_read_b32 v35, v34
s_waitcnt lgkmcnt(0)
v_readfirstlane_b32 s42, v35
s_nop 3
s_cmp_ge_u32 s42, 1
s_cbranch_scc1 L_cntd_15
s_sub_u32 s85, s85, 1
s_cmp_eq_u32 s85, 0
s_cbranch_scc1 L_cntd_15
s_sleep 1
s_branch L_cnt_14
L_cntd_15:
s_mov_b32 m0, s82
s_nop 0
buffer_load_dwordx4 v16, s[60:63], s79 offen lds
buffer_load_dwordx4 v17, s[60:63], s79 offen offset:1024 lds
buffer_load_dwordx4 v18, s[60:63], s79 offen offset:2048 lds
buffer_load_dwordx4 v19, s[60:63], s79 offen offset:3072 lds
s_add_u32 m0, m0, 4096
s_nop 0
buffer_load_dwordx4 v20, s[60:63], s79 offen lds
buffer_load_dwordx4 v21, s[60:63], s79 offen offset:1024 lds
buffer_load_dwordx4 v22, s[60:63], s79 offen offset:2048 lds
s_add_u32 s79, s79, 458752
s_add_u32 m0, s82, 45056
s_nop 0
buffer_load_dwordx4 v16, s[60:63], s79 offen lds
buffer_load_dwordx4 v17, s[60:63], s79 offen offset:1024 lds
buffer_load_dwordx4 v18, s[60:63], s79 offen offset:2048 lds
buffer_load_dwordx4 v19, s[60:63], s79 offen offset:3072 lds
s_add_u32 m0, m0, 4096
s_nop 0
buffer_load_dwordx4 v20, s[60:63], s79 offen lds
buffer_load_dwordx4 v21, s[60:63], s79 offen offset:1024 lds
buffer_load_dwordx4 v22, s[60:63], s79 offen offset:2048 lds
s_add_u32 s79, s79, 458752
s_add_u32 m0, s82, 90112
s_nop 0
buffer_load_dwordx4 v16, s[60:63], s79 offen lds
buffer_load_dwordx4 v17, s[60:63], s79 offen offset:1024 lds
buffer_load_dwordx4 v18, s[60:63], s79 offen offset:2048 lds
buffer_load_dwordx4 v19, s[60:63], s79 offen offset:3072 lds
s_add_u32 m0, m0, 4096
s_nop 0
buffer_load_dwordx4 v20, s[60:63], s79 offen lds
buffer_load_dwordx4 v21, s[60:63], s79 offen offset:1024 lds
buffer_load_dwordx4 v22, s[60:63], s79 offen offset:2048 lds
s_add_u32 s79, s79, 458752
v_mov_b32 v34, 155648
s_mov_b32 s85, 160000
L_gn_16:
ds_read_b64 v[32:33], v34
s_waitcnt lgkmcnt(0)
v_readfirstlane_b32 s40, v32
v_readfirstlane_b32 s41, v33
s_nop 2
s_cmp_lg_u32 s40, 0
s_cbranch_scc1 L_gnd_17
s_sub_u32 s85, s85, 1
s_cmp_eq_u32 s85, 0
s_cbranch_scc1 L_gnd_17
s_sleep 1
s_branch L_gn_16
L_gnd_17:
s_cmp_lg_u32 s38, 3
s_cbranch_scc1 L_only_18
s_lshl_b32 s44, s33, 7
s_add_u32 s44, s44, 41943040
v_min_u32 v34, 15, v1
v_lshlrev_b32 v34, 3, v34
s_mov_b32 s85, 20000
L_poll_19:
buffer_load_dwordx2 v[32:33], v34, s[28:31], s44 offen sc1
s_waitcnt vmcnt(0)
v_cmp_eq_u32 vcc, s40, v32
v_cmp_eq_u32 s[58:59], s41, v33
s_nop 3
s_and_b64 vcc, vcc, s[58:59]
s_cmp_eq_u64 vcc, exec
s_cbranch_scc1 L_polld_20
s_sub_u32 s85, s85, 1
s_cmp_eq_u32 s85, 0
s_cbranch_scc1 L_polld_20
s_sleep 1
s_branch L_poll_19
L_polld_20:
v_mov_b32 v34, 155680
v_mov_b32 v35, 1
s_mov_b64 exec, 1
ds_add_u32 v34, v35
s_mov_b64 exec, -1
L_only_18:
v_mov_b32 v34, 155680
s_mov_b32 s85, 20000
L_cnt_21:
ds_read_b32 v37, v34
s_waitcnt lgkmcnt(0)
v_readfirstlane_b32 s42, v37
s_nop 3
s_cmp_ge_u32 s42, 1
s_cbranch_scc1 L_cntd_22
s_sub_u32 s85, s85, 1
s_cmp_eq_u32 s85, 0
s_cbranch_scc1 L_cntd_22
s_sleep 1
s_branch L_cnt_21
L_cntd_22:
s_lshl_b32 s78, s33, 18
s_lshl_b32 s42, s38, 12
s_add_u32 s78, s78, s42
s_mov_b32 m0, s81
s_nop 0
buffer_load_dwordx4 v30, s[28:31], s78 offen lds
buffer_load_dwordx4 v30, s[28:31], s78 offen offset:1024 lds
buffer_load_dwordx4 v30, s[28:31], s78 offen offset:2048 lds
buffer_load_dwordx4 v30, s[28:31], s78 offen offset:3072 lds
s_add_u32 s78, s78, 16384
s_add_u32 m0, s81, 45056
s_nop 0
buffer_load_dwordx4 v30, s[28:31], s78 offen lds
buffer_load_dwordx4 v30, s[28:31], s78 offen offset:1024 lds
buffer_load_dwordx4 v30, s[28:31], s78 offen offset:2048 lds
buffer_load_dwordx4 v30, s[28:31], s78 offen offset:3072 lds
s_add_u32 s78, s78, 16384
s_add_u32 m0, s81, 90112
s_nop 0
buffer_load_dwordx4 v30, s[28:31], s78 offen lds
buffer_load_dwordx4 v30, s[28:31], s78 offen offset:1024 lds
buffer_load_dwordx4 v30, s[28:31], s78 offen offset:2048 lds
buffer_load_dwordx4 v30, s[28:31], s78 offen offset:3072 lds
s_add_u32 s78, s78, 16384
s_waitcnt vmcnt(8)
s_barrier
s_lshr_b32 s88, s2, 4
s_lshl_b32 s88, s88, 7
s_add_u32 s88, s88, 41947136
s_mov_b32 s77, 0
s_waitcnt vmcnt(4)
s_barrier
s_cmp_lg_u32 s38, 2
s_cbranch_scc1 L_only_23
s_lshl_b32 s42, s34, 7
s_lshl_b32 s43, s33, 3
s_add_u32 s42, s42, s43
s_add_u32 s42, s42, 41947136
v_mov_b32 v32, s40
v_mov_b32 v33, s41
v_mov_b32 v34, 0
s_mov_b64 exec, 1
buffer_store_dwordx2 v[32:33], v34, s[28:31], s42 offen sc1
s_mov_b64 exec, -1
L_only_23:
s_add_u32 m0, s81, s77
s_nop 0
buffer_load_dwordx4 v30, s[28:31], s78 offen lds
buffer_load_dwordx4 v30, s[28:31], s78 offen offset:1024 lds
buffer_load_dwordx4 v30, s[28:31], s78 offen offset:2048 lds
buffer_load_dwordx4 v30, s[28:31], s78 offen offset:3072 lds
s_add_u32 m0, s82, s77
s_nop 0
buffer_load_dwordx4 v16, s[60:63], s79 offen lds
buffer_load_dwordx4 v17, s[60:63], s79 offen offset:1024 lds
buffer_load_dwordx4 v18, s[60:63], s79 offen offset:2048 lds
buffer_load_dwordx4 v19, s[60:63], s79 offen offset:3072 lds
s_add_u32 m0, m0, 4096
s_nop 0
buffer_load_dwordx4 v20, s[60:63], s79 offen lds
buffer_load_dwordx4 v21, s[60:63], s79 offen offset:1024 lds
buffer_load_dwordx4 v22, s[60:63], s79 offen offset:2048 lds
s_add_u32 s78, s78, 16384
s_add_u32 s79, s79, 458752
s_add_u32 s77, s77, 45056
s_cmp_eq_u32 s77, 135168
s_cselect_b32 s77, 0, s77
s_cmp_lg_u32 s92, 0
s_cbranch_scc1 L_sx_24
s_mov_b32 s64, s16
s_mov_b32 s65, s17
s_mov_b32 s66, 7340032
s_mov_b32 s67, 0x20000
s_lshl_b32 s46, s2, 2
s_add_u32 s46, s46, s38
s_mul_i32 s46, s46, 7168
buffer_load_dword v124, v120, s[64:67], s46 offen
L_sx_24:
s_cmp_lg_u32 s93, 0
s_cbranch_scc1 L_sx_25
s_mov_b32 s64, s18
s_mov_b32 s65, s19
s_mov_b32 s66, 7340032
s_mov_b32 s67, 0x20000
s_lshl_b32 s46, s2, 2
s_add_u32 s46, s46, s38
s_mul_i32 s46, s46, 7168
buffer_load_dword v125, v120, s[64:67], s46 offen
L_sx_25:
s_cmp_lg_u32 s94, 0
s_cbranch_scc1 L_sx_26
s_lshl_b32 s42, s2, 2
s_add_u32 s42, s42, s38
s_lshl_b32 s42, s42, 12
s_add_u32 s72, s12, s42
s_addc_u32 s73, s13, 0
s_mov_b32 s74, 4096
s_mov_b32 s75, 0x20000
v_add_u32 v33, 16, v30
buffer_load_dwordx4 v[80:83], v30, s[72:75], 0 offen nt
buffer_load_dwordx4 v[88:91], v30, s[72:75], 0 offen offset:1024 nt
buffer_load_dwordx4 v[96:99], v30, s[72:75], 0 offen offset:2048 nt
buffer_load_dwordx4 v[104:107], v30, s[72:75], 0 offen offset:3072 nt
L_sx_26:
s_waitcnt vmcnt(11)
s_barrier
s_add_u32 m0, s81, s77
s_nop 0
buffer_load_dwordx4 v30, s[28:31], s78 offen lds
buffer_load_dwordx4 v30, s[28:31], s78 offen offset:1024 lds
buffer_load_dwordx4 v30, s[28:31], s78 offen offset:2048 lds
buffer_load_dwordx4 v30, s[28:31], s78 offen offset:3072 lds
s_add_u32 m0, s82, s77
s_nop 0
buffer_load_dwordx4 v16, s[60:63], s79 offen lds
buffer_load_dwordx4 v17, s[60:63], s79 offen offset:1024 lds
buffer_load_dwordx4 v18, s[60:63], s79 offen offset:2048 lds
buffer_load_dwordx4 v19, s[60:63], s79 offen offset:3072 lds
s_add_u32 m0, m0, 4096
s_nop 0
buffer_load_dwordx4 v20, s[60:63], s79 offen lds
buffer_load_dwordx4 v21, s[60:63], s79 offen offset:1024 lds
buffer_load_dwordx4 v22, s[60:63], s79 offen offset:2048 lds
s_add_u32 s78, s78, 16384
s_add_u32 s79, s79, 458752
s_add_u32 s77, s77, 45056
s_cmp_eq_u32 s77, 135168
s_cselect_b32 s77, 0, s77
s_cmp_lg_u32 s92, 1
s_cbranch_scc1 L_sx_27
s_mov_b32 s64, s16
s_mov_b32 s65, s17
s_mov_b32 s66, 7340032
s_mov_b32 s67, 0x20000
s_lshl_b32 s46, s2, 2
s_add_u32 s46, s46, s38
s_mul_i32 s46, s46, 7168
buffer_load_dword v124, v120, s[64:67], s46 offen
L_sx_27:
s_cmp_lg_u32 s93, 1
s_cbranch_scc1 L_sx_28
s_mov_b32 s64, s18
s_mov_b32 s65, s19
s_mov_b32 s66, 7340032
s_mov_b32 s67, 0x20000
s_lshl_b32 s46, s2, 2
s_add_u32 s46, s46, s38
s_mul_i32 s46, s46, 7168
buffer_load_dword v125, v120, s[64:67], s46 offen
L_sx_28:
s_cmp_lg_u32 s94, 1
s_cbranch_scc1 L_sx_29
s_lshl_b32 s42, s2, 2
s_add_u32 s42, s42, s38
s_lshl_b32 s42, s42, 12
s_add_u32 s72, s12, s42
s_addc_u32 s73, s13, 0
s_mov_b32 s74, 4096
s_mov_b32 s75, 0x20000
v_add_u32 v33, 16, v30
buffer_load_dwordx4 v[80:83], v30, s[72:75], 0 offen nt
buffer_load_dwordx4 v[88:91], v30, s[72:75], 0 offen offset:1024 nt
buffer_load_dwordx4 v[96:99], v30, s[72:75], 0 offen offset:2048 nt
buffer_load_dwordx4 v[104:107], v30, s[72:75], 0 offen offset:3072 nt
L_sx_29:
s_waitcnt vmcnt(11)
s_barrier
s_add_u32 m0, s81, s77
s_nop 0
buffer_load_dwordx4 v30, s[28:31], s78 offen lds
buffer_load_dwordx4 v30, s[28:31], s78 offen offset:1024 lds
buffer_load_dwordx4 v30, s[28:31], s78 offen offset:2048 lds
buffer_load_dwordx4 v30, s[28:31], s78 offen offset:3072 lds
s_add_u32 m0, s82, s77
s_nop 0
buffer_load_dwordx4 v16, s[60:63], s79 offen lds
buffer_load_dwordx4 v17, s[60:63], s79 offen offset:1024 lds
buffer_load_dwordx4 v18, s[60:63], s79 offen offset:2048 lds
buffer_load_dwordx4 v19, s[60:63], s79 offen offset:3072 lds
s_add_u32 m0, m0, 4096
s_nop 0
buffer_load_dwordx4 v20, s[60:63], s79 offen lds
buffer_load_dwordx4 v21, s[60:63], s79 offen offset:1024 lds
buffer_load_dwordx4 v22, s[60:63], s79 offen offset:2048 lds
s_add_u32 s78, s78, 16384
s_add_u32 s79, s79, 458752
s_add_u32 s77, s77, 45056
s_cmp_eq_u32 s77, 135168
s_cselect_b32 s77, 0, s77
s_cmp_lg_u32 s92, 2
s_cbranch_scc1 L_sx_30
s_mov_b32 s64, s16
s_mov_b32 s65, s17
s_mov_b32 s66, 7340032
s_mov_b32 s67, 0x20000
s_lshl_b32 s46, s2, 2
s_add_u32 s46, s46, s38
s_mul_i32 s46, s46, 7168
buffer_load_dword v124, v120, s[64:67], s46 offen
L_sx_30:
s_cmp_lg_u32 s93, 2
s_cbranch_scc1 L_sx_31
s_mov_b32 s64, s18
s_mov_b32 s65, s19
s_mov_b32 s66, 7340032
s_mov_b32 s67, 0x20000
s_lshl_b32 s46, s2, 2
s_add_u32 s46, s46, s38
s_mul_i32 s46, s46, 7168
buffer_load_dword v125, v120, s[64:67], s46 offen
L_sx_31:
s_cmp_lg_u32 s94, 2
s_cbranch_scc1 L_sx_32
s_lshl_b32 s42, s2, 2
s_add_u32 s42, s42, s38
s_lshl_b32 s42, s42, 12
s_add_u32 s72, s12, s42
s_addc_u32 s73, s13, 0
s_mov_b32 s74, 4096
s_mov_b32 s75, 0x20000
v_add_u32 v33, 16, v30
buffer_load_dwordx4 v[80:83], v30, s[72:75], 0 offen nt
buffer_load_dwordx4 v[88:91], v30, s[72:75], 0 offen offset:1024 nt
buffer_load_dwordx4 v[96:99], v30, s[72:75], 0 offen offset:2048 nt
buffer_load_dwordx4 v[104:107], v30, s[72:75], 0 offen offset:3072 nt
L_sx_32:
s_mov_b32 s80, 3
.p2align 6
L_h1:
s_waitcnt vmcnt(11)
s_barrier
L_h1_s:
s_add_u32 m0, s81, s77
s_nop 0
buffer_load_dwordx4 v30, s[28:31], s78 offen lds
buffer_load_dwordx4 v30, s[28:31], s78 offen offset:1024 lds
buffer_load_dwordx4 v30, s[28:31], s78 offen offset:2048 lds
buffer_load_dwordx4 v30, s[28:31], s78 offen offset:3072 lds
s_add_u32 m0, s82, s77
s_nop 0
buffer_load_dwordx4 v16, s[60:63], s79 offen lds
buffer_load_dwordx4 v17, s[60:63], s79 offen offset:1024 lds
buffer_load_dwordx4 v18, s[60:63], s79 offen offset:2048 lds
buffer_load_dwordx4 v19, s[60:63], s79 offen offset:3072 lds
s_add_u32 m0, m0, 4096
s_nop 0
buffer_load_dwordx4 v20, s[60:63], s79 offen lds
buffer_load_dwordx4 v21, s[60:63], s79 offen offset:1024 lds
buffer_load_dwordx4 v22, s[60:63], s79 offen offset:2048 lds
s_add_u32 s78, s78, 16384
s_add_u32 s79, s79, 458752
s_add_u32 s77, s77, 45056
s_cmp_eq_u32 s77, 135168
s_cselect_b32 s77, 0, s77
s_cmp_lg_u32 s92, s80
s_cbranch_scc1 L_sx_33
s_mov_b32 s64, s16
s_mov_b32 s65, s17
s_mov_b32 s66, 7340032
s_mov_b32 s67, 0x20000
s_lshl_b32 s46, s2, 2
s_add_u32 s46, s46, s38
s_mul_i32 s46, s46, 7168
buffer_load_dword v124, v120, s[64:67], s46 offen
L_sx_33:
s_cmp_lg_u32 s93, s80
s_cbranch_scc1 L_sx_34
s_mov_b32 s64, s18
s_mov_b32 s65, s19
s_mov_b32 s66, 7340032
s_mov_b32 s67, 0x20000
s_lshl_b32 s46, s2, 2
s_add_u32 s46, s46, s38
s_mul_i32 s46, s46, 7168
buffer_load_dword v125, v120, s[64:67], s46 offen
L_sx_34:
s_cmp_lg_u32 s94, s80
s_cbranch_scc1 L_sx_35
s_lshl_b32 s42, s2, 2
s_add_u32 s42, s42, s38
s_lshl_b32 s42, s42, 12
s_add_u32 s72, s12, s42
s_addc_u32 s73, s13, 0
s_mov_b32 s74, 4096
s_mov_b32 s75, 0x20000
v_add_u32 v33, 16, v30
buffer_load_dwordx4 v[80:83], v30, s[72:75], 0 offen nt
buffer_load_dwordx4 v[88:91], v30, s[72:75], 0 offen offset:1024 nt
buffer_load_dwordx4 v[96:99], v30, s[72:75], 0 offen offset:2048 nt
buffer_load_dwordx4 v[104:107], v30, s[72:75], 0 offen offset:3072 nt
L_sx_35:
s_cmp_eq_u32 s80, 4
s_cbranch_scc1 L_h1_fl
s_cmp_eq_u32 s80, 6
s_cbranch_scc1 L_h1_ur
L_h1_n:
s_add_u32 s80, s80, 1
s_cmp_le_u32 s80, 12
s_cbranch_scc1 L_h1
s_branch L_h1_d
L_h1_fl:
v_min_u32 v70, 15, v1
v_lshlrev_b32 v70, 3, v70
buffer_load_dwordx2 v[68:69], v70, s[28:31], s88 offen sc1
s_branch L_h1_n
L_h1_ur:
v_cmp_eq_u32 vcc, s40, v68
v_cmp_eq_u32 s[58:59], s41, v69
s_nop 3
s_and_b64 vcc, vcc, s[58:59]
s_cmp_eq_u64 vcc, exec
s_cbranch_scc1 L_chk_36
v_min_u32 v70, 15, v1
v_lshlrev_b32 v70, 3, v70
s_mov_b32 s85, 20000
L_poll_37:
buffer_load_dwordx2 v[68:69], v70, s[28:31], s88 offen sc1
s_waitcnt vmcnt(0)
v_cmp_eq_u32 vcc, s40, v68
v_cmp_eq_u32 s[58:59], s41, v69
s_nop 3
s_and_b64 vcc, vcc, s[58:59]
s_cmp_eq_u64 vcc, exec
s_cbranch_scc1 L_polld_38
s_sub_u32 s85, s85, 1
s_cmp_eq_u32 s85, 0
s_cbranch_scc1 L_polld_38
s_sleep 1
s_branch L_poll_37
L_polld_38:
L_chk_36:
s_lshl_b32 s42, s2, 2
s_add_u32 s42, s42, s38
s_lshl_b32 s42, s42, 12
s_add_u32 s42, s42, 20971520
s_add_u32 s68, s24, s42
s_addc_u32 s69, s25, 0
s_mov_b32 s70, 4096
s_mov_b32 s71, 0x20000
v_add_u32 v32, 4096, v30
s_mul_i32 s44, s38, 5120
s_add_u32 m0, s44, 135168
s_nop 0
buffer_load_dwordx4 v30, s[68:71], 0 offen lds
buffer_load_dwordx4 v30, s[68:71], 0 offen offset:1024 lds
buffer_load_dwordx4 v30, s[68:71], 0 offen offset:2048 lds
buffer_load_dwordx4 v30, s[68:71], 0 offen offset:3072 lds
s_add_u32 m0, m0, 4096
s_nop 0
buffer_load_dwordx4 v32, s[68:71], 0 offen lds
s_branch L_h1_n
L_h1_d:
s_waitcnt vmcnt(11)
s_barrier
s_waitcnt vmcnt(0)
s_barrier
s_mul_i32 s42, s38, 16640
s_add_u32 s42, s42, 65536
v_add_u32 v32, s42, v30
v_mov_b32 v84, 0
s_nop 1
v_mov_b32_dpp v84, v80 wave_shl:1 row_mask:0xf bank_mask:0xf
v_readlane_b32 s46, v88, 0
s_nop 1
v_writelane_b32 v84, s46, 63
v_mov_b32 v85, 0
s_nop 1
v_mov_b32_dpp v85, v81 wave_shl:1 row_mask:0xf bank_mask:0xf
v_readlane_b32 s47, v89, 0
s_nop 1
v_writelane_b32 v85, s47, 63
ds_write_b128 v32, v[80:83] offset:32
v_alignbit_b32 v160, v81, v80, 16
v_alignbit_b32 v161, v82, v81, 16
v_alignbit_b32 v162, v83, v82, 16
v_alignbit_b32 v163, v84, v83, 16
v_mov_b32 v164, v81
v_mov_b32 v165, v82
v_mov_b32 v166, v83
v_mov_b32 v167, v84
v_mov_b32 v168, v161
v_mov_b32 v169, v162
v_mov_b32 v170, v163
v_alignbit_b32 v171, v85, v84, 16
ds_write_b128 v32, v[160:163] offset:4192
ds_write_b128 v32, v[164:167] offset:8352
ds_write_b128 v32, v[168:171] offset:12512
v_mov_b32 v92, 0
s_nop 1
v_mov_b32_dpp v92, v88 wave_shl:1 row_mask:0xf bank_mask:0xf
v_readlane_b32 s46, v96, 0
s_nop 1
v_writelane_b32 v92, s46, 63
v_mov_b32 v93, 0
s_nop 1
v_mov_b32_dpp v93, v89 wave_shl:1 row_mask:0xf bank_mask:0xf
v_readlane_b32 s47, v97, 0
s_nop 1
v_writelane_b32 v93, s47, 63
ds_write_b128 v32, v[88:91] offset:1056
v_alignbit_b32 v172, v89, v88, 16
v_alignbit_b32 v173, v90, v89, 16
v_alignbit_b32 v174, v91, v90, 16
v_alignbit_b32 v175, v92, v91, 16
v_mov_b32 v176, v89
v_mov_b32 v177, v90
v_mov_b32 v178, v91
v_mov_b32 v179, v92
v_mov_b32 v180, v173
v_mov_b32 v181, v174
v_mov_b32 v182, v175
v_alignbit_b32 v183, v93, v92, 16
ds_write_b128 v32, v[172:175] offset:5216
ds_write_b128 v32, v[176:179] offset:9376
ds_write_b128 v32, v[180:183] offset:13536
s_barrier
v_mov_b32 v100, 0
s_nop 1
v_mov_b32_dpp v100, v96 wave_shl:1 row_mask:0xf bank_mask:0xf
v_readlane_b32 s46, v104, 0
s_nop 1
v_writelane_b32 v100, s46, 63
v_mov_b32 v101, 0
s_nop 1
v_mov_b32_dpp v101, v97 wave_shl:1 row_mask:0xf bank_mask:0xf
v_readlane_b32 s47, v105, 0
s_nop 1
v_writelane_b32 v101, s47, 63
ds_write_b128 v32, v[96:99] offset:2080
v_alignbit_b32 v160, v97, v96, 16
v_alignbit_b32 v161, v98, v97, 16
v_alignbit_b32 v162, v99, v98, 16
v_alignbit_b32 v163, v100, v99, 16
v_mov_b32 v164, v97
v_mov_b32 v165, v98
v_mov_b32 v166, v99
v_mov_b32 v167, v100
v_mov_b32 v168, v161
v_mov_b32 v169, v162
v_mov_b32 v170, v163
v_alignbit_b32 v171, v101, v100, 16
ds_write_b128 v32, v[160:163] offset:6240
ds_write_b128 v32, v[164:167] offset:10400
ds_write_b128 v32, v[168:171] offset:14560
v_mov_b32 v108, 0
s_nop 1
v_mov_b32_dpp v108, v104 wave_shl:1 row_mask:0xf bank_mask:0xf
v_mov_b32 v109, 0
s_nop 1
v_mov_b32_dpp v109, v105 wave_shl:1 row_mask:0xf bank_mask:0xf
ds_write_b128 v32, v[104:107] offset:3104
v_alignbit_b32 v172, v105, v104, 16
v_alignbit_b32 v173, v106, v105, 16
v_alignbit_b32 v174, v107, v106, 16
v_alignbit_b32 v175, v108, v107, 16
v_mov_b32 v176, v105
v_mov_b32 v177, v106
v_mov_b32 v178, v107
v_mov_b32 v179, v108
v_mov_b32 v180, v173
v_mov_b32 v181, v174
v_mov_b32 v182, v175
v_alignbit_b32 v183, v109, v108, 16
ds_write_b128 v32, v[172:175] offset:7264
ds_write_b128 v32, v[176:179] offset:11424
ds_write_b128 v32, v[180:183] offset:15584
v_readlane_b32 s44, v80, 0
v_readlane_b32 s45, v81, 0
v_and_b32 v33, 3, v1
v_mul_u32_u24 v34, 4160, v33
v_add_u32 v34, s42, v34
v_mov_b32 v36, s44
v_mov_b32 v37, s45
v_mov_b32 v40, 0
v_mov_b32 v41, 0
v_mov_b32 v42, 0
v_mov_b32 v43, 0
v_mov_b32 v44, 0
v_mov_b32 v45, 0
v_mov_b32 v46, 0
v_mov_b32 v47, 0
v_lshlrev_b32 v38, 16, v36
v_alignbit_b32 v39, v37, v36, 16
v_cmp_eq_u32 vcc, 1, v33
s_nop 1
v_cndmask_b32 v47, v47, v38, vcc
v_cmp_eq_u32 vcc, 2, v33
s_nop 1
v_cndmask_b32 v47, v47, v36, vcc
v_cmp_eq_u32 vcc, 3, v33
s_nop 1
v_cndmask_b32 v47, v47, v39, vcc
v_cndmask_b32 v46, v46, v38, vcc
s_mov_b64 exec, 0xf
ds_write_b128 v34, v[40:43]
ds_write_b128 v34, v[44:47] offset:16
s_mov_b64 exec, -1
s_waitcnt lgkmcnt(0)
s_barrier
s_mul_i32 s42, s38, 14336
v_add_u32 v33, s42, v30
s_mul_i32 s43, s33, 917504
s_mul_i32 s44, s34, 57344
s_add_u32 s43, s43, s44
s_add_u32 s43, s43, s42
s_add_u32 s43, s43, 4194304
ds_read_b128 v[64:67], v33 offset:0
ds_read_b128 v[68:71], v33 offset:1024
ds_read_b128 v[72:75], v33 offset:2048
ds_read_b128 v[76:79], v33 offset:3072
ds_read_b128 v[80:83], v33 offset:4096
ds_read_b128 v[84:87], v33 offset:5120
ds_read_b128 v[88:91], v33 offset:6144
ds_read_b128 v[92:95], v33 offset:7168
ds_read_b128 v[96:99], v33 offset:8192
ds_read_b128 v[100:103], v33 offset:9216
ds_read_b128 v[104:107], v33 offset:10240
ds_read_b128 v[108:111], v33 offset:11264
ds_read_b128 v[112:115], v33 offset:12288
ds_read_b128 v[116:119], v33 offset:13312
s_waitcnt lgkmcnt(13)
buffer_store_dwordx4 v[64:67], v30, s[28:31], s43 offen sc1
s_add_u32 s43, s43, 1024
s_waitcnt lgkmcnt(12)
buffer_store_dwordx4 v[68:71], v30, s[28:31], s43 offen sc1
s_add_u32 s43, s43, 1024
s_waitcnt lgkmcnt(11)
buffer_store_dwordx4 v[72:75], v30, s[28:31], s43 offen sc1
s_add_u32 s43, s43, 1024
s_waitcnt lgkmcnt(10)
buffer_store_dwordx4 v[76:79], v30, s[28:31], s43 offen sc1
s_add_u32 s43, s43, 1024
s_waitcnt lgkmcnt(9)
buffer_store_dwordx4 v[80:83], v30, s[28:31], s43 offen sc1
s_add_u32 s43, s43, 1024
s_waitcnt lgkmcnt(8)
buffer_store_dwordx4 v[84:87], v30, s[28:31], s43 offen sc1
s_add_u32 s43, s43, 1024
s_waitcnt lgkmcnt(7)
buffer_store_dwordx4 v[88:91], v30, s[28:31], s43 offen sc1
s_add_u32 s43, s43, 1024
s_waitcnt lgkmcnt(6)
buffer_store_dwordx4 v[92:95], v30, s[28:31], s43 offen sc1
s_add_u32 s43, s43, 1024
s_waitcnt lgkmcnt(5)
buffer_store_dwordx4 v[96:99], v30, s[28:31], s43 offen sc1
s_add_u32 s43, s43, 1024
s_waitcnt lgkmcnt(4)
buffer_store_dwordx4 v[100:103], v30, s[28:31], s43 offen sc1
s_add_u32 s43, s43, 1024
s_waitcnt lgkmcnt(3)
buffer_store_dwordx4 v[104:107], v30, s[28:31], s43 offen sc1
s_add_u32 s43, s43, 1024
s_waitcnt lgkmcnt(2)
buffer_store_dwordx4 v[108:111], v30, s[28:31], s43 offen sc1
s_add_u32 s43, s43, 1024
s_waitcnt lgkmcnt(1)
buffer_store_dwordx4 v[112:115], v30, s[28:31], s43 offen sc1
s_add_u32 s43, s43, 1024
s_waitcnt lgkmcnt(0)
buffer_store_dwordx4 v[116:119], v30, s[28:31], s43 offen sc1
s_add_u32 s43, s43, 1024
v_mov_b32 v34, 155656
v_mov_b32 v35, 1
s_mov_b64 exec, 1
ds_add_u32 v34, v35
s_mov_b64 exec, -1
s_mul_i32 s42, s37, 3670016
s_add_u32 s60, s18, s42
s_addc_u32 s61, s19, 0
s_sub_u32 s62, 7340032, s42
s_mov_b32 s63, 0x20000
v_lshrrev_b32 v40, 4, v1
v_and_b32 v41, 15, v1
v_add_u32 v42, 0, v40
v_and_b32 v43, 7, v42
v_lshlrev_b32 v43, 1, v43
v_xor_b32 v43, v43, v41
v_cmp_gt_u32 vcc, 8, v43
v_mov_b32 v44, s97
v_mov_b32 v45, s96
v_cndmask_b32 v44, v44, v45, vcc
v_lshlrev_b32 v44, 7, v44
v_and_b32 v43, 7, v43
v_lshlrev_b32 v43, 4, v43
v_add_u32 v43, v43, v44
s_lshl_b32 s42, s38, 4
v_add_u32 v42, s42, v42
v_lshlrev_b32 v42, 11, v42
v_add_u32 v16, v42, v43
v_add_u32 v42, 4, v40
v_and_b32 v43, 7, v42
v_lshlrev_b32 v43, 1, v43
v_xor_b32 v43, v43, v41
v_cmp_gt_u32 vcc, 8, v43
v_mov_b32 v44, s97
v_mov_b32 v45, s96
v_cndmask_b32 v44, v44, v45, vcc
v_lshlrev_b32 v44, 7, v44
v_and_b32 v43, 7, v43
v_lshlrev_b32 v43, 4, v43
v_add_u32 v43, v43, v44
s_lshl_b32 s42, s38, 4
v_add_u32 v42, s42, v42
v_lshlrev_b32 v42, 11, v42
v_add_u32 v17, v42, v43
v_subrev_u32 v17, 1024, v17
v_add_u32 v42, 8, v40
v_and_b32 v43, 7, v42
v_lshlrev_b32 v43, 1, v43
v_xor_b32 v43, v43, v41
v_cmp_gt_u32 vcc, 8, v43
v_mov_b32 v44, s97
v_mov_b32 v45, s96
v_cndmask_b32 v44, v44, v45, vcc
v_lshlrev_b32 v44, 7, v44
v_and_b32 v43, 7, v43
v_lshlrev_b32 v43, 4, v43
v_add_u32 v43, v43, v44
s_lshl_b32 s42, s38, 4
v_add_u32 v42, s42, v42
v_lshlrev_b32 v42, 11, v42
v_add_u32 v18, v42, v43
v_subrev_u32 v18, 2048, v18
v_add_u32 v42, 12, v40
v_and_b32 v43, 7, v42
v_lshlrev_b32 v43, 1, v43
v_xor_b32 v43, v43, v41
v_cmp_gt_u32 vcc, 8, v43
v_mov_b32 v44, s97
v_mov_b32 v45, s96
v_cndmask_b32 v44, v44, v45, vcc
v_lshlrev_b32 v44, 7, v44
v_and_b32 v43, 7, v43
v_lshlrev_b32 v43, 4, v43
v_add_u32 v43, v43, v44
s_lshl_b32 s42, s38, 4
v_add_u32 v42, s42, v42
v_lshlrev_b32 v42, 11, v42
v_add_u32 v19, v42, v43
v_subrev_u32 v19, 3072, v19
s_lshl_b32 s82, s38, 12
s_add_u32 s82, s82, 16384
s_mul_i32 s78, s35, 917504
s_mul_i32 s42, s37, 458752
s_add_u32 s78, s78, s42
s_lshl_b32 s42, s38, 12
s_add_u32 s78, s78, s42
s_add_u32 s78, s78, 4194304
s_mov_b32 s79, 0
v_lshrrev_b32 v44, 4, v1
v_and_b32 v45, 15, v1
v_add_u32 v46, 0, v44
v_lshlrev_b32 v46, 1, v46
v_xor_b32 v46, v46, v45
v_lshlrev_b32 v46, 4, v46
v_lshlrev_b32 v47, 8, v44
v_add_u32 v24, v46, v47
v_add_u32 v46, 4, v44
v_lshlrev_b32 v46, 1, v46
v_xor_b32 v46, v46, v45
v_lshlrev_b32 v46, 4, v46
v_lshlrev_b32 v47, 8, v44
v_add_u32 v25, v46, v47
s_lshl_b32 s89, s35, 5
s_lshl_b32 s43, s95, 1
s_add_u32 s89, s89, s43
s_lshl_b32 s89, s89, 13
s_lshl_b32 s43, s38, 12
s_add_u32 s89, s89, s43
s_add_u32 s89, s89, 25165824
s_mov_b32 s72, s4
s_mov_b32 s73, s5
s_mov_b32 s74, 4194304
s_mov_b32 s75, 0x20000
v_lshrrev_b32 v44, 3, v1
v_and_b32 v45, 7, v1
v_add_u32 v46, 0, v44
v_bfe_u32 v47, v46, 1, 3
v_xor_b32 v47, v47, v45
v_lshlrev_b32 v47, 4, v47
v_lshlrev_b32 v46, 11, v46
v_add_u32 v26, v46, v47
v_add_u32 v46, 8, v44
v_bfe_u32 v47, v46, 1, 3
v_xor_b32 v47, v47, v45
v_lshlrev_b32 v47, 4, v47
v_lshlrev_b32 v46, 11, v46
v_add_u32 v27, v46, v47
v_subrev_u32 v27, 1024, v27
v_add_u32 v46, 16, v44
v_bfe_u32 v47, v46, 1, 3
v_xor_b32 v47, v47, v45
v_lshlrev_b32 v47, 4, v47
v_lshlrev_b32 v46, 11, v46
v_add_u32 v28, v46, v47
v_subrev_u32 v28, 2048, v28
v_add_u32 v46, 24, v44
v_bfe_u32 v47, v46, 1, 3
v_xor_b32 v47, v47, v45
v_lshlrev_b32 v47, 4, v47
v_lshlrev_b32 v46, 11, v46
v_add_u32 v29, v46, v47
v_subrev_u32 v29, 3072, v29
s_lshl_b32 s90, s35, 18
s_lshl_b32 s43, s38, 16
s_add_u32 s90, s90, s43
s_lshl_b32 s43, s95, 7
s_add_u32 s90, s90, s43
s_lshl_b32 s91, s95, 14
s_lshl_b32 s43, s35, 18
s_add_u32 s91, s91, s43
s_lshl_b32 s43, s38, 12
s_add_u32 s91, s91, s43
s_mov_b32 s85, 20000
L_cnt_39:
ds_read_b32 v37, v34
s_waitcnt lgkmcnt(0)
v_readfirstlane_b32 s42, v37
s_nop 3
s_cmp_ge_u32 s42, 4
s_cbranch_scc1 L_cntd_40
s_sub_u32 s85, s85, 1
s_cmp_eq_u32 s85, 0
s_cbranch_scc1 L_cntd_40
s_sleep 1
s_branch L_cnt_39
L_cntd_40:
s_mov_b32 m0, s82
s_nop 0
buffer_load_dwordx4 v16, s[60:63], s79 offen lds
buffer_load_dwordx4 v17, s[60:63], s79 offen offset:1024 lds
buffer_load_dwordx4 v18, s[60:63], s79 offen offset:2048 lds
buffer_load_dwordx4 v19, s[60:63], s79 offen offset:3072 lds
s_add_u32 s79, s79, 131072
s_add_u32 m0, s82, 32768
s_nop 0
buffer_load_dwordx4 v16, s[60:63], s79 offen lds
buffer_load_dwordx4 v17, s[60:63], s79 offen offset:1024 lds
buffer_load_dwordx4 v18, s[60:63], s79 offen offset:2048 lds
buffer_load_dwordx4 v19, s[60:63], s79 offen offset:3072 lds
s_add_u32 s79, s79, 131072
s_waitcnt vmcnt(8)
s_mov_b64 exec, 1
ds_add_rtn_u32 v36, v34, v35 offset:4
s_mov_b64 exec, -1
s_waitcnt lgkmcnt(0)
v_readfirstlane_b32 s42, v36
s_nop 3
s_cmp_lg_u32 s42, 3
s_cbranch_scc1 L_sk_41
s_lshl_b32 s42, s33, 7
s_lshl_b32 s43, s34, 3
s_add_u32 s42, s42, s43
s_add_u32 s42, s42, 41951232
v_mov_b32 v36, s40
v_mov_b32 v37, s41
v_mov_b32 v38, 0
s_mov_b64 exec, 1
buffer_store_dwordx2 v[36:37], v38, s[28:31], s42 offen sc1
s_mov_b64 exec, -1
s_lshl_b32 s44, s35, 7
s_lshl_b32 s45, s37, 6
s_add_u32 s44, s44, s45
s_add_u32 s44, s44, 41951232
v_min_u32 v40, 1, v1
v_lshlrev_b32 v40, 3, v40
s_mov_b32 s85, 20000
L_poll_42:
buffer_load_dwordx2 v[38:39], v40, s[28:31], s44 offen sc1
s_waitcnt vmcnt(0)
v_cmp_eq_u32 vcc, s40, v38
v_cmp_eq_u32 s[58:59], s41, v39
s_nop 3
s_and_b64 vcc, vcc, s[58:59]
s_cmp_eq_u64 vcc, exec
s_cbranch_scc1 L_polld_43
s_sub_u32 s85, s85, 1
s_cmp_eq_u32 s85, 0
s_cbranch_scc1 L_polld_43
s_sleep 1
s_branch L_poll_42
L_polld_43:
v_mov_b32 v34, 155676
v_mov_b32 v35, 1
s_mov_b64 exec, 1
ds_add_u32 v34, v35
s_mov_b64 exec, -1
L_sk_41:
v_mov_b32 v34, 155676
s_mov_b32 s85, 20000
L_cnt_44:
ds_read_b32 v37, v34
s_waitcnt lgkmcnt(0)
v_readfirstlane_b32 s42, v37
s_nop 3
s_cmp_ge_u32 s42, 1
s_cbranch_scc1 L_cntd_45
s_sub_u32 s85, s85, 1
s_cmp_eq_u32 s85, 0
s_cbranch_scc1 L_cntd_45
s_sleep 1
s_branch L_cnt_44
L_cntd_45:
s_mov_b32 m0, s81
s_nop 0
buffer_load_dwordx4 v30, s[28:31], s78 offen lds
buffer_load_dwordx4 v30, s[28:31], s78 offen offset:1024 lds
buffer_load_dwordx4 v30, s[28:31], s78 offen offset:2048 lds
buffer_load_dwordx4 v30, s[28:31], s78 offen offset:3072 lds
s_add_u32 s78, s78, 16384
s_add_u32 m0, s81, 32768
s_nop 0
buffer_load_dwordx4 v30, s[28:31], s78 offen lds
buffer_load_dwordx4 v30, s[28:31], s78 offen offset:1024 lds
buffer_load_dwordx4 v30, s[28:31], s78 offen offset:2048 lds
buffer_load_dwordx4 v30, s[28:31], s78 offen offset:3072 lds
s_add_u32 s78, s78, 16384
v_mov_b32 v34, 155684
s_mov_b32 s85, 20000
L_cnt_46:
ds_read_b32 v37, v34
s_waitcnt lgkmcnt(0)
v_readfirstlane_b32 s42, v37
s_nop 3
s_cmp_ge_u32 s42, 4
s_cbranch_scc1 L_cntd_47
s_sub_u32 s85, s85, 1
s_cmp_eq_u32 s85, 0
s_cbranch_scc1 L_cntd_47
s_sleep 1
s_branch L_cnt_46
L_cntd_47:
s_add_u32 m0, s81, 65536
s_nop 0
buffer_load_dwordx4 v30, s[28:31], s78 offen lds
buffer_load_dwordx4 v30, s[28:31], s78 offen offset:1024 lds
buffer_load_dwordx4 v30, s[28:31], s78 offen offset:2048 lds
buffer_load_dwordx4 v30, s[28:31], s78 offen offset:3072 lds
s_add_u32 s78, s78, 16384
s_add_u32 m0, s82, 65536
s_nop 0
buffer_load_dwordx4 v16, s[60:63], s79 offen lds
buffer_load_dwordx4 v17, s[60:63], s79 offen offset:1024 lds
buffer_load_dwordx4 v18, s[60:63], s79 offen offset:2048 lds
buffer_load_dwordx4 v19, s[60:63], s79 offen offset:3072 lds
s_add_u32 s79, s79, 131072
s_waitcnt vmcnt(12)
s_barrier
s_lshl_b32 s88, s95, 7
s_add_u32 s88, s88, 41955328
s_mov_b32 s77, 98304
s_waitcnt vmcnt(8)
s_barrier
s_cmp_lg_u32 s38, 2
s_cbranch_scc1 L_only_48
s_lshl_b32 s42, s2, 3
s_add_u32 s42, s42, 41955328
v_mov_b32 v36, s40
v_mov_b32 v37, s41
v_mov_b32 v38, 0
s_mov_b64 exec, 1
buffer_store_dwordx2 v[36:37], v38, s[28:31], s42 offen sc1
s_mov_b64 exec, -1
L_only_48:
s_add_u32 m0, s81, s77
s_nop 0
buffer_load_dwordx4 v30, s[28:31], s78 offen lds
buffer_load_dwordx4 v30, s[28:31], s78 offen offset:1024 lds
buffer_load_dwordx4 v30, s[28:31], s78 offen offset:2048 lds
buffer_load_dwordx4 v30, s[28:31], s78 offen offset:3072 lds
s_add_u32 m0, s82, s77
s_nop 0
buffer_load_dwordx4 v16, s[60:63], s79 offen lds
buffer_load_dwordx4 v17, s[60:63], s79 offen offset:1024 lds
buffer_load_dwordx4 v18, s[60:63], s79 offen offset:2048 lds
buffer_load_dwordx4 v19, s[60:63], s79 offen offset:3072 lds
s_add_u32 s78, s78, 16384
s_add_u32 s79, s79, 131072
s_add_u32 s77, s77, 32768
s_cmp_eq_u32 s77, 163840
s_cselect_b32 s77, 0, s77
s_add_u32 m0, s81, s77
s_nop 0
buffer_load_dwordx4 v30, s[28:31], s78 offen lds
buffer_load_dwordx4 v30, s[28:31], s78 offen offset:1024 lds
buffer_load_dwordx4 v30, s[28:31], s78 offen offset:2048 lds
buffer_load_dwordx4 v30, s[28:31], s78 offen offset:3072 lds
s_add_u32 m0, s82, s77
s_nop 0
buffer_load_dwordx4 v16, s[60:63], s79 offen lds
buffer_load_dwordx4 v17, s[60:63], s79 offen offset:1024 lds
buffer_load_dwordx4 v18, s[60:63], s79 offen offset:2048 lds
buffer_load_dwordx4 v19, s[60:63], s79 offen offset:3072 lds
s_add_u32 s78, s78, 16384
s_add_u32 s79, s79, 131072
s_add_u32 s77, s77, 32768
s_cmp_eq_u32 s77, 163840
s_cselect_b32 s77, 0, s77
s_waitcnt vmcnt(16)
s_barrier
s_add_u32 m0, s81, s77
s_nop 0
buffer_load_dwordx4 v30, s[28:31], s78 offen lds
buffer_load_dwordx4 v30, s[28:31], s78 offen offset:1024 lds
buffer_load_dwordx4 v30, s[28:31], s78 offen offset:2048 lds
buffer_load_dwordx4 v30, s[28:31], s78 offen offset:3072 lds
s_add_u32 m0, s82, s77
s_nop 0
buffer_load_dwordx4 v16, s[60:63], s79 offen lds
buffer_load_dwordx4 v17, s[60:63], s79 offen offset:1024 lds
buffer_load_dwordx4 v18, s[60:63], s79 offen offset:2048 lds
buffer_load_dwordx4 v19, s[60:63], s79 offen offset:3072 lds
s_add_u32 s78, s78, 16384
s_add_u32 s79, s79, 131072
s_add_u32 s77, s77, 32768
s_cmp_eq_u32 s77, 163840
s_cselect_b32 s77, 0, s77
s_lshl_b32 s87, s35, 7
s_lshl_b32 s45, s37, 6
s_add_u32 s87, s87, s45
s_add_u32 s87, s87, 41951232
v_min_u32 v70, 7, v1
v_lshlrev_b32 v70, 3, v70
buffer_load_dwordx2 v[68:69], v70, s[28:31], s87 offen sc1
s_waitcnt vmcnt(16)
s_barrier
s_add_u32 m0, s81, s77
s_nop 0
buffer_load_dwordx4 v30, s[28:31], s78 offen lds
buffer_load_dwordx4 v30, s[28:31], s78 offen offset:1024 lds
buffer_load_dwordx4 v30, s[28:31], s78 offen offset:2048 lds
buffer_load_dwordx4 v30, s[28:31], s78 offen offset:3072 lds
s_add_u32 m0, s82, s77
s_nop 0
buffer_load_dwordx4 v16, s[60:63], s79 offen lds
buffer_load_dwordx4 v17, s[60:63], s79 offen offset:1024 lds
buffer_load_dwordx4 v18, s[60:63], s79 offen offset:2048 lds
buffer_load_dwordx4 v19, s[60:63], s79 offen offset:3072 lds
s_add_u32 s78, s78, 16384
s_add_u32 s79, s79, 131072
s_add_u32 s77, s77, 32768
s_cmp_eq_u32 s77, 163840
s_cselect_b32 s77, 0, s77
s_mov_b32 s80, 3
.p2align 6
L_h2:
s_waitcnt vmcnt(16)
s_cmp_eq_u32 s80, 22
s_cbranch_scc1 L_h2_chk
L_h2_b:
s_barrier
s_cmp_eq_u32 s80, 3
s_cbranch_scc1 L_h2_hf
L_h2_s:
s_add_u32 m0, s81, s77
s_nop 0
buffer_load_dwordx4 v30, s[28:31], s78 offen lds
buffer_load_dwordx4 v30, s[28:31], s78 offen offset:1024 lds
buffer_load_dwordx4 v30, s[28:31], s78 offen offset:2048 lds
buffer_load_dwordx4 v30, s[28:31], s78 offen offset:3072 lds
s_add_u32 m0, s82, s77
s_nop 0
buffer_load_dwordx4 v16, s[60:63], s79 offen lds
buffer_load_dwordx4 v17, s[60:63], s79 offen offset:1024 lds
buffer_load_dwordx4 v18, s[60:63], s79 offen offset:2048 lds
buffer_load_dwordx4 v19, s[60:63], s79 offen offset:3072 lds
s_add_u32 s78, s78, 16384
s_add_u32 s79, s79, 131072
s_add_u32 s77, s77, 32768
s_cmp_eq_u32 s77, 163840
s_cselect_b32 s77, 0, s77
s_cmp_eq_u32 s80, 18
s_cbranch_scc1 L_h2_fl
L_h2_n:
s_add_u32 s80, s80, 1
s_cmp_le_u32 s80, 23
s_cbranch_scc1 L_h2
s_branch L_h2_d
L_h2_hf:
s_waitcnt vmcnt(8)
v_cmp_eq_u32 vcc, s40, v68
v_cmp_eq_u32 s[58:59], s41, v69
s_nop 3
s_and_b64 vcc, vcc, s[58:59]
s_cmp_eq_u64 vcc, exec
s_cbranch_scc1 L_chk_49
v_min_u32 v70, 7, v1
v_lshlrev_b32 v70, 3, v70
s_mov_b32 s85, 20000
L_poll_50:
buffer_load_dwordx2 v[68:69], v70, s[28:31], s87 offen sc1
s_waitcnt vmcnt(0)
v_cmp_eq_u32 vcc, s40, v68
v_cmp_eq_u32 s[58:59], s41, v69
s_nop 3
s_and_b64 vcc, vcc, s[58:59]
s_cmp_eq_u64 vcc, exec
s_cbranch_scc1 L_polld_51
s_sub_u32 s85, s85, 1
s_cmp_eq_u32 s85, 0
s_cbranch_scc1 L_polld_51
s_sleep 1
s_branch L_poll_50
L_polld_51:
L_chk_49:
s_branch L_h2_s
L_h2_chk:
v_cmp_eq_u32 vcc, s40, v68
v_cmp_eq_u32 s[58:59], s41, v69
s_nop 3
s_and_b64 vcc, vcc, s[58:59]
s_cmp_eq_u64 vcc, exec
s_cbranch_scc1 L_chk_52
v_min_u32 v70, 15, v1
v_lshlrev_b32 v70, 3, v70
s_mov_b32 s85, 20000
L_poll_53:
buffer_load_dwordx2 v[68:69], v70, s[28:31], s88 offen sc1
s_waitcnt vmcnt(0)
v_cmp_eq_u32 vcc, s40, v68
v_cmp_eq_u32 s[58:59], s41, v69
s_nop 3
s_and_b64 vcc, vcc, s[58:59]
s_cmp_eq_u64 vcc, exec
s_cbranch_scc1 L_polld_54
s_sub_u32 s85, s85, 1
s_cmp_eq_u32 s85, 0
s_cbranch_scc1 L_polld_54
s_sleep 1
s_branch L_poll_53
L_polld_54:
L_chk_52:
s_branch L_h2_b
L_h2_fl:
v_min_u32 v70, 15, v1
v_lshlrev_b32 v70, 3, v70
buffer_load_dwordx2 v[68:69], v70, s[28:31], s88 offen sc1
s_branch L_h2_n
L_h2_d:
v_and_b32 v32, 31, v1
v_lshlrev_b32 v33, 7, v32
v_lshlrev_b32 v34, 11, v32
v_cmp_gt_u32 vcc, 32, v1
v_mov_b32 v35, s89
v_mov_b32 v36, s91
v_cndmask_b32 v35, v36, v35, vcc
v_add_u32 v33, v33, v35
buffer_load_dword v124, v33, s[28:31], 0 offen
s_mov_b64 exec, 0xffffffff
buffer_load_dword v125, v34, s[72:75], s90 offen
s_mov_b64 exec, -1
s_waitcnt vmcnt(18)
s_barrier
s_waitcnt vmcnt(2)
s_barrier
s_lshl_b32 s43, s38, 12
s_add_u32 m0, s43, 98304
s_nop 0
buffer_load_dwordx4 v24, s[28:31], s89 offen lds
buffer_load_dwordx4 v25, s[28:31], s89 offen offset:1024 lds
buffer_load_dwordx4 v24, s[28:31], s89 offen offset:2048 lds
buffer_load_dwordx4 v25, s[28:31], s89 offen offset:3072 lds
s_lshl_b32 s43, s38, 12
s_add_u32 m0, s43, 131072
s_nop 0
buffer_load_dwordx4 v30, s[28:31], s91 offen lds
buffer_load_dwordx4 v30, s[28:31], s91 offen offset:1024 lds
buffer_load_dwordx4 v30, s[28:31], s91 offen offset:2048 lds
buffer_load_dwordx4 v30, s[28:31], s91 offen offset:3072 lds
s_lshl_b32 s43, s38, 12
s_add_u32 m0, s43, 114688
s_nop 0
buffer_load_dwordx4 v26, s[72:75], s90 offen lds
buffer_load_dwordx4 v27, s[72:75], s90 offen offset:1024 lds
buffer_load_dwordx4 v28, s[72:75], s90 offen offset:2048 lds
buffer_load_dwordx4 v29, s[72:75], s90 offen offset:3072 lds
s_waitcnt vmcnt(8)
s_waitcnt vmcnt(4)
s_waitcnt vmcnt(0)
s_barrier
s_cmp_lg_u32 s38, 2
s_cbranch_scc1 L_only_55
s_lshl_b32 s42, s2, 7
s_add_u32 s42, s42, 41959424
v_mov_b32 v32, s40
v_mov_b32 v33, s41
v_mov_b32 v34, 0
s_mov_b64 exec, 1
buffer_store_dwordx2 v[32:33], v34, s[28:31], s42 offen sc1
s_mov_b64 exec, -1
s_xor_b32 s44, s2, 1
s_lshl_b32 s44, s44, 7
s_add_u32 s44, s44, 41959424
v_min_u32 v34, 0, v1
v_lshlrev_b32 v34, 3, v34
s_mov_b32 s85, 20000
L_poll_56:
buffer_load_dwordx2 v[32:33], v34, s[28:31], s44 offen sc1
s_waitcnt vmcnt(0)
v_cmp_eq_u32 vcc, s40, v32
v_cmp_eq_u32 s[58:59], s41, v33
s_nop 3
s_and_b64 vcc, vcc, s[58:59]
s_cmp_eq_u64 vcc, exec
s_cbranch_scc1 L_polld_57
s_sub_u32 s85, s85, 1
s_cmp_eq_u32 s85, 0
s_cbranch_scc1 L_polld_57
s_sleep 1
s_branch L_poll_56
L_polld_57:
L_only_55:
s_barrier
s_branch L_exit
L_exit:
s_endpgm
.section .rodata,"a"
.p2align 6
.amdhsa_kernel parallel_sum__ssm_conv_h3__dense_activation_relu__prompt_kernel
.amdhsa_next_free_vgpr 256
.amdhsa_next_free_sgpr 102
.amdhsa_accum_offset 256
.amdhsa_group_segment_fixed_size 0
.amdhsa_kernarg_size 96
.amdhsa_user_sgpr_count 2
.amdhsa_user_sgpr_kernarg_segment_ptr 1
.amdhsa_system_sgpr_workgroup_id_x 1
.end_amdhsa_kernel
.text
```
